```python
import torch

def _softmax(x, axis=-1):
    return torch.softmax(x, dim=axis)

def _gelu(x):
    return torch.nn.functional.gelu(x, approximate='tanh')

def _silu(x):
    return torch.nn.functional.silu(x)

def _sigmoid(x):
    return torch.sigmoid(x)

def _layernorm(x, axis=-1, eps=1e-05):
    m = x.mean(dim=axis, keepdim=True)
    v = x.var(dim=axis, keepdim=True, unbiased=False)
    return (x - m) / torch.sqrt(v + eps)

def _scatter_add(tgt, idx, src, axis=0):
    return tgt.clone().index_add_(axis, idx, src)

def _segment_sum(src, seg, n):
    out = torch.zeros((n,) + src.shape[1:], dtype=src.dtype)
    return out.index_add_(0, seg, src)

def _pad(x, pw):
    flat = tuple((v for pair in reversed(pw) for v in pair))
    return torch.nn.functional.pad(x, flat)
kernel_name = 'standalone__tree_speculative_verify_tree_attention_over_candidate_token_tree__sampling'

def setup_inputs():

    _w = lambda a: (lambda t: t.to(torch.bfloat16) if t.is_floating_point() else t)(torch.as_tensor(a))
    B, Hq, Hkv, T, C, D = (8, 16, 8, 32, 2048, 256)
    tree_mask = torch.zeros((B, T, T), dtype=float)
    for b in range(B):
        parent = torch.zeros(T, dtype=torch.int64)
        for i in range(1, T):
            parent[i] = int(torch.randint(0, i, (1,)).item())
        for i in range(T):
            j = i
            tree_mask[b, i, j] = 1.0
            while j > 0:
                j = parent[j]
                tree_mask[b, i, j] = 1.0
    return {'q': _w((lambda *s: torch.randn(*s, dtype=torch.bfloat16) * 0.8)(B, Hq, T, D)), 'k_cache': _w((lambda *s: torch.randn(*s, dtype=torch.bfloat16) * 0.8)(B, Hkv, C, D)), 'v_cache': _w((lambda *s: torch.randn(*s, dtype=torch.bfloat16) * 0.05)(B, Hkv, C, D)), 'k_tree': _w((lambda *s: torch.randn(*s, dtype=torch.bfloat16) * 0.8)(B, Hkv, T, D)), 'v_tree': _w((lambda *s: torch.randn(*s, dtype=torch.bfloat16) * 0.05)(B, Hkv, T, D)), 'tree_mask': _w(tree_mask)}

def reference(q, k_cache, v_cache, k_tree, v_tree, tree_mask):
    B, Hq, T, D = q.shape
    Hkv, C = (k_cache.shape[1], k_cache.shape[2])
    rep = Hq // Hkv
    kc = (lambda x, n, axis: torch.repeat_interleave(x, n, dim=axis))(k_cache, rep, axis=1)
    vc = (lambda x, n, axis: torch.repeat_interleave(x, n, dim=axis))(v_cache, rep, axis=1)
    kt = (lambda x, n, axis: torch.repeat_interleave(x, n, dim=axis))(k_tree, rep, axis=1)
    vt = (lambda x, n, axis: torch.repeat_interleave(x, n, dim=axis))(v_tree, rep, axis=1)
    k = torch.concatenate([kc, kt], axis=2)
    v = torch.concatenate([vc, vt], axis=2)
    scale = D ** (-0.5)
    scores = torch.einsum('bhqd,bhkd->bhqk', q, k) * scale
    ctx_mask = torch.ones((B, 1, T, C), dtype=scores.dtype)
    tm = tree_mask[:, None, :, :].clone()
    full_mask = torch.concatenate([ctx_mask, tm], axis=-1)
    scores = scores + (1.0 - full_mask) * -1000000000.0
    p = _softmax(scores, axis=-1)
    return torch.einsum('bhqk,bhkd->bhqd', p, v)
```

```asm
; @launch grid=(256,1,1) block=(512,1,1) lds=114752
.amdgcn_target "amdgcn-amd-amdhsa--gfx950"
.text
.globl standalone__tree_speculative_verify_tree_attention_over_candidate_token_tree__sampling_kernel
.p2align 8
.type standalone__tree_speculative_verify_tree_attention_over_candidate_token_tree__sampling_kernel,@function
standalone__tree_speculative_verify_tree_attention_over_candidate_token_tree__sampling_kernel:
    s_cmp_ge_u32 s2, 256
    s_cbranch_scc1 L_end
    s_load_dwordx16 s[16:31], s[0:1], 0
    s_load_dwordx2 s[32:33], s[0:1], 64
    s_and_b32 s3, s2, 7
    s_lshr_b32 s4, s2, 5
    s_lshl_b32 s4, s4, 3
    s_or_b32 s3, s3, s4
    s_lshr_b32 s4, s2, 3
    s_and_b32 s4, s4, 3
    s_lshr_b32 s34, s4, 1
    s_and_b32 s35, s4, 1
    v_lshrrev_b32 v1, 6, v0
    v_and_b32 v2, 63, v0
    v_readfirstlane_b32 s5, v1
    s_lshl_b32 s13, s35, 8
    s_lshl_b32 s6, s34, 7
    s_xor_b32 s7, s6, 128
    s_add_u32 s12, s13, s7
    s_add_u32 s13, s13, s6
    s_cmp_lt_u32 s5, 4
    s_cbranch_scc1 L_compute
    s_sub_u32 s5, s5, 4
    v_lshrrev_b32 v3, 5, v2
    s_lshl_b32 s6, s5, 3
    v_add_u32 v3, s6, v3
    v_and_b32 v4, 31, v2
    v_add_u32 v5, 0, v3
    v_and_b32 v5, 15, v5
    v_xor_b32 v5, v5, v4
    v_lshlrev_b32 v5, 4, v5
    v_lshl_add_u32 v10, v3, 9, v5
    v_add_u32 v5, 2, v3
    v_and_b32 v5, 15, v5
    v_xor_b32 v5, v5, v4
    v_lshlrev_b32 v5, 4, v5
    v_lshl_add_u32 v11, v3, 9, v5
    v_add_u32 v5, 4, v3
    v_and_b32 v5, 15, v5
    v_xor_b32 v5, v5, v4
    v_lshlrev_b32 v5, 4, v5
    v_lshl_add_u32 v12, v3, 9, v5
    v_add_u32 v5, 6, v3
    v_and_b32 v5, 15, v5
    v_xor_b32 v5, v5, v4
    v_lshlrev_b32 v5, 4, v5
    v_lshl_add_u32 v13, v3, 9, v5
    s_lshl_b32 s8, s5, 12
    s_mul_i32 s11, s35, 0
    s_lshl_b32 s6, s3, 20
    s_lshl_b32 s7, s34, 19
    s_add_u32 s6, s6, s7
    s_lshl_b32 s7, s3, 14
    s_waitcnt lgkmcnt(0)
    s_add_u32 s36, s18, s6
    s_addc_u32 s37, s19, 0
    s_mov_b32 s38, 0x80000
    s_mov_b32 s39, 0x20000
    s_add_u32 m0, s8, 0
    s_mov_b32 s10, 0
    buffer_load_dwordx4 v10, s[36:39], s10 offen offset:0 nt lds
    buffer_load_dwordx4 v11, s[36:39], s10 offen offset:1024 nt lds
    buffer_load_dwordx4 v12, s[36:39], s10 offen offset:2048 nt lds
    buffer_load_dwordx4 v13, s[36:39], s10 offen offset:3072 nt lds
    s_add_u32 m0, s8, 16384
    s_mov_b32 s10, 16384
    buffer_load_dwordx4 v10, s[36:39], s10 offen offset:0 nt lds
    buffer_load_dwordx4 v11, s[36:39], s10 offen offset:1024 nt lds
    buffer_load_dwordx4 v12, s[36:39], s10 offen offset:2048 nt lds
    buffer_load_dwordx4 v13, s[36:39], s10 offen offset:3072 nt lds
    s_add_u32 m0, s8, 32768
    s_mov_b32 s10, 32768
    buffer_load_dwordx4 v10, s[36:39], s10 offen offset:0 nt lds
    buffer_load_dwordx4 v11, s[36:39], s10 offen offset:1024 nt lds
    buffer_load_dwordx4 v12, s[36:39], s10 offen offset:2048 nt lds
    buffer_load_dwordx4 v13, s[36:39], s10 offen offset:3072 nt lds
    s_add_u32 m0, s8, 49152
    s_mov_b32 s10, 49152
    buffer_load_dwordx4 v10, s[36:39], s10 offen offset:0 nt lds
    buffer_load_dwordx4 v11, s[36:39], s10 offen offset:1024 nt lds
    buffer_load_dwordx4 v12, s[36:39], s10 offen offset:2048 nt lds
    buffer_load_dwordx4 v13, s[36:39], s10 offen offset:3072 nt lds
    s_add_u32 m0, s8, 65536
    s_mov_b32 s10, 65536
    buffer_load_dwordx4 v10, s[36:39], s10 offen offset:0 nt lds
    buffer_load_dwordx4 v11, s[36:39], s10 offen offset:1024 nt lds
    buffer_load_dwordx4 v12, s[36:39], s10 offen offset:2048 nt lds
    buffer_load_dwordx4 v13, s[36:39], s10 offen offset:3072 nt lds
    s_add_u32 s40, s20, s6
    s_addc_u32 s41, s21, 0
    s_mov_b32 s42, 0x80000
    s_mov_b32 s43, 0x20000
    s_add_u32 s44, s22, s7
    s_addc_u32 s45, s23, 0
    s_mov_b32 s46, 0x4000
    s_mov_b32 s47, 0x20000
    s_add_u32 s48, s24, s7
    s_addc_u32 s49, s25, 0
    s_mov_b32 s50, 0x4000
    s_mov_b32 s51, 0x20000
    v_lshrrev_b32 v3, 3, v2
    v_and_b32 v4, 7, v2
    v_lshrrev_b32 v5, 1, v4
    v_lshrrev_b32 v6, 4, v2
    v_and_b32 v6, 3, v6
    v_xor_b32 v5, v5, v6
    v_and_b32 v6, 1, v4
    v_lshl_add_u32 v5, v5, 1, v6
    v_lshlrev_b32 v5, 4, v5
    v_lshl_add_u32 v5, v3, 9, v5
    s_lshl_b32 s6, s5, 12
    v_add_u32 v18, s6, v5
    s_lshl_b32 s6, s5, 14
    s_xor_b32 s6, s6, s11
    v_add_u32 v5, s6, v5
    v_add_u32 v14, 0, v5
    v_add_u32 v15, 3072, v5
    v_add_u32 v16, 6144, v5
    v_add_u32 v17, 9216, v5
    s_lshl_b32 s9, s5, 10
    s_waitcnt vmcnt(16)
    s_barrier
    s_add_u32 m0, s8, 81920
    s_mov_b32 s10, 81920
    buffer_load_dwordx4 v10, s[36:39], s10 offen offset:0 nt lds
    buffer_load_dwordx4 v11, s[36:39], s10 offen offset:1024 nt lds
    buffer_load_dwordx4 v12, s[36:39], s10 offen offset:2048 nt lds
    buffer_load_dwordx4 v13, s[36:39], s10 offen offset:3072 nt lds
    s_waitcnt vmcnt(16)
    s_barrier
    s_add_u32 m0, s8, 98304
    s_mov_b32 s10, 98304
    buffer_load_dwordx4 v10, s[36:39], s10 offen offset:0 nt lds
    buffer_load_dwordx4 v11, s[36:39], s10 offen offset:1024 nt lds
    buffer_load_dwordx4 v12, s[36:39], s10 offen offset:2048 nt lds
    buffer_load_dwordx4 v13, s[36:39], s10 offen offset:3072 nt lds
    s_waitcnt vmcnt(16)
    s_barrier
    s_add_u32 m0, s8, 0
    s_mov_b32 s10, 114688
    buffer_load_dwordx4 v10, s[36:39], s10 offen offset:0 nt lds
    buffer_load_dwordx4 v11, s[36:39], s10 offen offset:1024 nt lds
    buffer_load_dwordx4 v12, s[36:39], s10 offen offset:2048 nt lds
    buffer_load_dwordx4 v13, s[36:39], s10 offen offset:3072 nt lds
    s_waitcnt vmcnt(16)
    s_barrier
    s_add_u32 m0, s8, 16384
    s_add_u32 s10, s12, 0
    buffer_load_dwordx4 v14, s[40:43], s10 offen offset:0 nt lds
    buffer_load_dwordx4 v15, s[40:43], s10 offen offset:1024 nt lds
    buffer_load_dwordx4 v16, s[40:43], s10 offen offset:2048 nt lds
    buffer_load_dwordx4 v17, s[40:43], s10 offen offset:3072 nt lds
    s_waitcnt vmcnt(16)
    s_barrier
    s_add_u32 m0, s8, 32768
    s_mov_b32 s10, 131072
    buffer_load_dwordx4 v10, s[36:39], s10 offen offset:0 nt lds
    buffer_load_dwordx4 v11, s[36:39], s10 offen offset:1024 nt lds
    buffer_load_dwordx4 v12, s[36:39], s10 offen offset:2048 nt lds
    buffer_load_dwordx4 v13, s[36:39], s10 offen offset:3072 nt lds
    s_waitcnt vmcnt(16)
    s_barrier
    s_add_u32 m0, s8, 49152
    s_mov_b32 s10, 147456
    buffer_load_dwordx4 v10, s[36:39], s10 offen offset:0 nt lds
    buffer_load_dwordx4 v11, s[36:39], s10 offen offset:1024 nt lds
    buffer_load_dwordx4 v12, s[36:39], s10 offen offset:2048 nt lds
    buffer_load_dwordx4 v13, s[36:39], s10 offen offset:3072 nt lds
    s_waitcnt vmcnt(16)
    s_barrier
    s_add_u32 m0, s8, 65536
    s_mov_b32 s10, 163840
    buffer_load_dwordx4 v10, s[36:39], s10 offen offset:0 nt lds
    buffer_load_dwordx4 v11, s[36:39], s10 offen offset:1024 nt lds
    buffer_load_dwordx4 v12, s[36:39], s10 offen offset:2048 nt lds
    buffer_load_dwordx4 v13, s[36:39], s10 offen offset:3072 nt lds
    s_waitcnt vmcnt(16)
    s_barrier
    s_add_u32 m0, s8, 81920
    s_mov_b32 s10, 180224
    buffer_load_dwordx4 v10, s[36:39], s10 offen offset:0 nt lds
    buffer_load_dwordx4 v11, s[36:39], s10 offen offset:1024 nt lds
    buffer_load_dwordx4 v12, s[36:39], s10 offen offset:2048 nt lds
    buffer_load_dwordx4 v13, s[36:39], s10 offen offset:3072 nt lds
    s_waitcnt vmcnt(16)
    s_barrier
    s_add_u32 m0, s8, 98304
    s_add_u32 s10, s12, 65536
    buffer_load_dwordx4 v14, s[40:43], s10 offen offset:0 nt lds
    buffer_load_dwordx4 v15, s[40:43], s10 offen offset:1024 nt lds
    buffer_load_dwordx4 v16, s[40:43], s10 offen offset:2048 nt lds
    buffer_load_dwordx4 v17, s[40:43], s10 offen offset:3072 nt lds
    s_waitcnt vmcnt(16)
    s_barrier
    s_add_u32 m0, s8, 0
    s_mov_b32 s10, 196608
    buffer_load_dwordx4 v10, s[36:39], s10 offen offset:0 nt lds
    buffer_load_dwordx4 v11, s[36:39], s10 offen offset:1024 nt lds
    buffer_load_dwordx4 v12, s[36:39], s10 offen offset:2048 nt lds
    buffer_load_dwordx4 v13, s[36:39], s10 offen offset:3072 nt lds
    s_waitcnt vmcnt(16)
    s_barrier
    s_add_u32 m0, s8, 16384
    s_mov_b32 s10, 212992
    buffer_load_dwordx4 v10, s[36:39], s10 offen offset:0 nt lds
    buffer_load_dwordx4 v11, s[36:39], s10 offen offset:1024 nt lds
    buffer_load_dwordx4 v12, s[36:39], s10 offen offset:2048 nt lds
    buffer_load_dwordx4 v13, s[36:39], s10 offen offset:3072 nt lds
    s_waitcnt vmcnt(16)
    s_barrier
    s_add_u32 m0, s8, 32768
    s_mov_b32 s10, 229376
    buffer_load_dwordx4 v10, s[36:39], s10 offen offset:0 nt lds
    buffer_load_dwordx4 v11, s[36:39], s10 offen offset:1024 nt lds
    buffer_load_dwordx4 v12, s[36:39], s10 offen offset:2048 nt lds
    buffer_load_dwordx4 v13, s[36:39], s10 offen offset:3072 nt lds
    s_waitcnt vmcnt(16)
    s_barrier
    s_add_u32 m0, s8, 49152
    s_mov_b32 s10, 245760
    buffer_load_dwordx4 v10, s[36:39], s10 offen offset:0 nt lds
    buffer_load_dwordx4 v11, s[36:39], s10 offen offset:1024 nt lds
    buffer_load_dwordx4 v12, s[36:39], s10 offen offset:2048 nt lds
    buffer_load_dwordx4 v13, s[36:39], s10 offen offset:3072 nt lds
    s_waitcnt vmcnt(16)
    s_barrier
    s_add_u32 m0, s8, 65536
    s_add_u32 s10, s12, 131072
    buffer_load_dwordx4 v14, s[40:43], s10 offen offset:0 nt lds
    buffer_load_dwordx4 v15, s[40:43], s10 offen offset:1024 nt lds
    buffer_load_dwordx4 v16, s[40:43], s10 offen offset:2048 nt lds
    buffer_load_dwordx4 v17, s[40:43], s10 offen offset:3072 nt lds
    s_waitcnt vmcnt(16)
    s_barrier
    s_add_u32 m0, s8, 81920
    s_mov_b32 s10, 262144
    buffer_load_dwordx4 v10, s[36:39], s10 offen offset:0 nt lds
    buffer_load_dwordx4 v11, s[36:39], s10 offen offset:1024 nt lds
    buffer_load_dwordx4 v12, s[36:39], s10 offen offset:2048 nt lds
    buffer_load_dwordx4 v13, s[36:39], s10 offen offset:3072 nt lds
    s_waitcnt vmcnt(16)
    s_barrier
    s_add_u32 m0, s8, 98304
    s_mov_b32 s10, 278528
    buffer_load_dwordx4 v10, s[36:39], s10 offen offset:0 nt lds
    buffer_load_dwordx4 v11, s[36:39], s10 offen offset:1024 nt lds
    buffer_load_dwordx4 v12, s[36:39], s10 offen offset:2048 nt lds
    buffer_load_dwordx4 v13, s[36:39], s10 offen offset:3072 nt lds
    s_waitcnt vmcnt(16)
    s_barrier
    s_add_u32 m0, s8, 0
    s_mov_b32 s10, 294912
    buffer_load_dwordx4 v10, s[36:39], s10 offen offset:0 nt lds
    buffer_load_dwordx4 v11, s[36:39], s10 offen offset:1024 nt lds
    buffer_load_dwordx4 v12, s[36:39], s10 offen offset:2048 nt lds
    buffer_load_dwordx4 v13, s[36:39], s10 offen offset:3072 nt lds
    s_waitcnt vmcnt(16)
    s_barrier
    s_add_u32 m0, s8, 16384
    s_mov_b32 s10, 311296
    buffer_load_dwordx4 v10, s[36:39], s10 offen offset:0 nt lds
    buffer_load_dwordx4 v11, s[36:39], s10 offen offset:1024 nt lds
    buffer_load_dwordx4 v12, s[36:39], s10 offen offset:2048 nt lds
    buffer_load_dwordx4 v13, s[36:39], s10 offen offset:3072 nt lds
    s_waitcnt vmcnt(16)
    s_barrier
    s_add_u32 m0, s8, 32768
    s_add_u32 s10, s12, 196608
    buffer_load_dwordx4 v14, s[40:43], s10 offen offset:0 nt lds
    buffer_load_dwordx4 v15, s[40:43], s10 offen offset:1024 nt lds
    buffer_load_dwordx4 v16, s[40:43], s10 offen offset:2048 nt lds
    buffer_load_dwordx4 v17, s[40:43], s10 offen offset:3072 nt lds
    s_waitcnt vmcnt(16)
    s_barrier
    s_add_u32 m0, s8, 49152
    s_mov_b32 s10, 327680
    buffer_load_dwordx4 v10, s[36:39], s10 offen offset:0 nt lds
    buffer_load_dwordx4 v11, s[36:39], s10 offen offset:1024 nt lds
    buffer_load_dwordx4 v12, s[36:39], s10 offen offset:2048 nt lds
    buffer_load_dwordx4 v13, s[36:39], s10 offen offset:3072 nt lds
    s_waitcnt vmcnt(16)
    s_barrier
    s_add_u32 m0, s8, 65536
    s_mov_b32 s10, 344064
    buffer_load_dwordx4 v10, s[36:39], s10 offen offset:0 nt lds
    buffer_load_dwordx4 v11, s[36:39], s10 offen offset:1024 nt lds
    buffer_load_dwordx4 v12, s[36:39], s10 offen offset:2048 nt lds
    buffer_load_dwordx4 v13, s[36:39], s10 offen offset:3072 nt lds
    s_waitcnt vmcnt(16)
    s_barrier
    s_add_u32 m0, s8, 81920
    s_mov_b32 s10, 360448
    buffer_load_dwordx4 v10, s[36:39], s10 offen offset:0 nt lds
    buffer_load_dwordx4 v11, s[36:39], s10 offen offset:1024 nt lds
    buffer_load_dwordx4 v12, s[36:39], s10 offen offset:2048 nt lds
    buffer_load_dwordx4 v13, s[36:39], s10 offen offset:3072 nt lds
    s_waitcnt vmcnt(16)
    s_barrier
    s_add_u32 m0, s8, 98304
    s_mov_b32 s10, 376832
    buffer_load_dwordx4 v10, s[36:39], s10 offen offset:0 nt lds
    buffer_load_dwordx4 v11, s[36:39], s10 offen offset:1024 nt lds
    buffer_load_dwordx4 v12, s[36:39], s10 offen offset:2048 nt lds
    buffer_load_dwordx4 v13, s[36:39], s10 offen offset:3072 nt lds
    s_waitcnt vmcnt(16)
    s_barrier
    s_add_u32 m0, s8, 0
    s_add_u32 s10, s12, 262144
    buffer_load_dwordx4 v14, s[40:43], s10 offen offset:0 nt lds
    buffer_load_dwordx4 v15, s[40:43], s10 offen offset:1024 nt lds
    buffer_load_dwordx4 v16, s[40:43], s10 offen offset:2048 nt lds
    buffer_load_dwordx4 v17, s[40:43], s10 offen offset:3072 nt lds
    s_waitcnt vmcnt(16)
    s_barrier
    s_add_u32 m0, s8, 16384
    s_mov_b32 s10, 393216
    buffer_load_dwordx4 v10, s[36:39], s10 offen offset:0 nt lds
    buffer_load_dwordx4 v11, s[36:39], s10 offen offset:1024 nt lds
    buffer_load_dwordx4 v12, s[36:39], s10 offen offset:2048 nt lds
    buffer_load_dwordx4 v13, s[36:39], s10 offen offset:3072 nt lds
    s_waitcnt vmcnt(16)
    s_barrier
    s_add_u32 m0, s8, 32768
    s_mov_b32 s10, 409600
    buffer_load_dwordx4 v10, s[36:39], s10 offen offset:0 nt lds
    buffer_load_dwordx4 v11, s[36:39], s10 offen offset:1024 nt lds
    buffer_load_dwordx4 v12, s[36:39], s10 offen offset:2048 nt lds
    buffer_load_dwordx4 v13, s[36:39], s10 offen offset:3072 nt lds
    s_waitcnt vmcnt(16)
    s_barrier
    s_add_u32 m0, s8, 49152
    s_mov_b32 s10, 425984
    buffer_load_dwordx4 v10, s[36:39], s10 offen offset:0 nt lds
    buffer_load_dwordx4 v11, s[36:39], s10 offen offset:1024 nt lds
    buffer_load_dwordx4 v12, s[36:39], s10 offen offset:2048 nt lds
    buffer_load_dwordx4 v13, s[36:39], s10 offen offset:3072 nt lds
    s_waitcnt vmcnt(16)
    s_barrier
    s_add_u32 m0, s8, 65536
    s_mov_b32 s10, 442368
    buffer_load_dwordx4 v10, s[36:39], s10 offen offset:0 nt lds
    buffer_load_dwordx4 v11, s[36:39], s10 offen offset:1024 nt lds
    buffer_load_dwordx4 v12, s[36:39], s10 offen offset:2048 nt lds
    buffer_load_dwordx4 v13, s[36:39], s10 offen offset:3072 nt lds
    s_waitcnt vmcnt(16)
    s_barrier
    s_add_u32 m0, s8, 81920
    s_add_u32 s10, s12, 327680
    buffer_load_dwordx4 v14, s[40:43], s10 offen offset:0 nt lds
    buffer_load_dwordx4 v15, s[40:43], s10 offen offset:1024 nt lds
    buffer_load_dwordx4 v16, s[40:43], s10 offen offset:2048 nt lds
    buffer_load_dwordx4 v17, s[40:43], s10 offen offset:3072 nt lds
    s_waitcnt vmcnt(16)
    s_barrier
    s_add_u32 m0, s8, 98304
    s_mov_b32 s10, 458752
    buffer_load_dwordx4 v10, s[36:39], s10 offen offset:0 nt lds
    buffer_load_dwordx4 v11, s[36:39], s10 offen offset:1024 nt lds
    buffer_load_dwordx4 v12, s[36:39], s10 offen offset:2048 nt lds
    buffer_load_dwordx4 v13, s[36:39], s10 offen offset:3072 nt lds
    s_waitcnt vmcnt(16)
    s_barrier
    s_add_u32 m0, s8, 0
    s_mov_b32 s10, 475136
    buffer_load_dwordx4 v10, s[36:39], s10 offen offset:0 nt lds
    buffer_load_dwordx4 v11, s[36:39], s10 offen offset:1024 nt lds
    buffer_load_dwordx4 v12, s[36:39], s10 offen offset:2048 nt lds
    buffer_load_dwordx4 v13, s[36:39], s10 offen offset:3072 nt lds
    s_waitcnt vmcnt(16)
    s_barrier
    s_add_u32 m0, s8, 16384
    s_mov_b32 s10, 491520
    buffer_load_dwordx4 v10, s[36:39], s10 offen offset:0 nt lds
    buffer_load_dwordx4 v11, s[36:39], s10 offen offset:1024 nt lds
    buffer_load_dwordx4 v12, s[36:39], s10 offen offset:2048 nt lds
    buffer_load_dwordx4 v13, s[36:39], s10 offen offset:3072 nt lds
    s_waitcnt vmcnt(16)
    s_barrier
    s_add_u32 m0, s8, 32768
    s_mov_b32 s10, 507904
    buffer_load_dwordx4 v10, s[36:39], s10 offen offset:0 nt lds
    buffer_load_dwordx4 v11, s[36:39], s10 offen offset:1024 nt lds
    buffer_load_dwordx4 v12, s[36:39], s10 offen offset:2048 nt lds
    buffer_load_dwordx4 v13, s[36:39], s10 offen offset:3072 nt lds
    s_waitcnt vmcnt(16)
    s_barrier
    s_add_u32 m0, s8, 49152
    s_add_u32 s10, s12, 393216
    buffer_load_dwordx4 v14, s[40:43], s10 offen offset:0 nt lds
    buffer_load_dwordx4 v15, s[40:43], s10 offen offset:1024 nt lds
    buffer_load_dwordx4 v16, s[40:43], s10 offen offset:2048 nt lds
    buffer_load_dwordx4 v17, s[40:43], s10 offen offset:3072 nt lds
    s_waitcnt vmcnt(16)
    s_barrier
    s_add_u32 m0, s8, 65536
    s_add_u32 s10, s12, 458752
    buffer_load_dwordx4 v14, s[40:43], s10 offen offset:0 nt lds
    buffer_load_dwordx4 v15, s[40:43], s10 offen offset:1024 nt lds
    buffer_load_dwordx4 v16, s[40:43], s10 offen offset:2048 nt lds
    buffer_load_dwordx4 v17, s[40:43], s10 offen offset:3072 nt lds
    s_waitcnt vmcnt(16)
    s_barrier
    s_add_u32 m0, s8, 81920
    s_mov_b32 s10, 0
    buffer_load_dwordx4 v10, s[44:47], s10 offen offset:0 lds
    buffer_load_dwordx4 v11, s[44:47], s10 offen offset:1024 lds
    buffer_load_dwordx4 v12, s[44:47], s10 offen offset:2048 lds
    buffer_load_dwordx4 v13, s[44:47], s10 offen offset:3072 lds
    s_waitcnt vmcnt(16)
    s_barrier
    s_add_u32 m0, s8, 98304
    s_add_u32 s10, s13, 0
    buffer_load_dwordx4 v14, s[40:43], s10 offen offset:0 nt lds
    buffer_load_dwordx4 v15, s[40:43], s10 offen offset:1024 nt lds
    buffer_load_dwordx4 v16, s[40:43], s10 offen offset:2048 nt lds
    buffer_load_dwordx4 v17, s[40:43], s10 offen offset:3072 nt lds
    s_waitcnt vmcnt(16)
    s_barrier
    s_add_u32 m0, s8, 0
    s_add_u32 s10, s13, 65536
    buffer_load_dwordx4 v14, s[40:43], s10 offen offset:0 nt lds
    buffer_load_dwordx4 v15, s[40:43], s10 offen offset:1024 nt lds
    buffer_load_dwordx4 v16, s[40:43], s10 offen offset:2048 nt lds
    buffer_load_dwordx4 v17, s[40:43], s10 offen offset:3072 nt lds
    s_waitcnt vmcnt(16)
    s_barrier
    s_add_u32 m0, s8, 16384
    s_add_u32 s10, s13, 131072
    buffer_load_dwordx4 v14, s[40:43], s10 offen offset:0 nt lds
    buffer_load_dwordx4 v15, s[40:43], s10 offen offset:1024 nt lds
    buffer_load_dwordx4 v16, s[40:43], s10 offen offset:2048 nt lds
    buffer_load_dwordx4 v17, s[40:43], s10 offen offset:3072 nt lds
    s_waitcnt vmcnt(16)
    s_barrier
    s_add_u32 m0, s8, 32768
    s_add_u32 s10, s13, 196608
    buffer_load_dwordx4 v14, s[40:43], s10 offen offset:0 nt lds
    buffer_load_dwordx4 v15, s[40:43], s10 offen offset:1024 nt lds
    buffer_load_dwordx4 v16, s[40:43], s10 offen offset:2048 nt lds
    buffer_load_dwordx4 v17, s[40:43], s10 offen offset:3072 nt lds
    s_waitcnt vmcnt(16)
    s_barrier
    s_add_u32 m0, s8, 49152
    s_add_u32 s10, s13, 262144
    buffer_load_dwordx4 v14, s[40:43], s10 offen offset:0 nt lds
    buffer_load_dwordx4 v15, s[40:43], s10 offen offset:1024 nt lds
    buffer_load_dwordx4 v16, s[40:43], s10 offen offset:2048 nt lds
    buffer_load_dwordx4 v17, s[40:43], s10 offen offset:3072 nt lds
    s_waitcnt vmcnt(16)
    s_barrier
    s_add_u32 m0, s8, 65536
    s_add_u32 s10, s13, 327680
    buffer_load_dwordx4 v14, s[40:43], s10 offen offset:0 nt lds
    buffer_load_dwordx4 v15, s[40:43], s10 offen offset:1024 nt lds
    buffer_load_dwordx4 v16, s[40:43], s10 offen offset:2048 nt lds
    buffer_load_dwordx4 v17, s[40:43], s10 offen offset:3072 nt lds
    s_waitcnt vmcnt(16)
    s_barrier
    s_add_u32 m0, s8, 81920
    s_add_u32 s10, s13, 393216
    buffer_load_dwordx4 v14, s[40:43], s10 offen offset:0 nt lds
    buffer_load_dwordx4 v15, s[40:43], s10 offen offset:1024 nt lds
    buffer_load_dwordx4 v16, s[40:43], s10 offen offset:2048 nt lds
    buffer_load_dwordx4 v17, s[40:43], s10 offen offset:3072 nt lds
    s_waitcnt vmcnt(16)
    s_barrier
    s_add_u32 m0, s8, 98304
    s_add_u32 s10, s13, 458752
    buffer_load_dwordx4 v14, s[40:43], s10 offen offset:0 nt lds
    buffer_load_dwordx4 v15, s[40:43], s10 offen offset:1024 nt lds
    buffer_load_dwordx4 v16, s[40:43], s10 offen offset:2048 nt lds
    buffer_load_dwordx4 v17, s[40:43], s10 offen offset:3072 nt lds
    s_waitcnt vmcnt(16)
    s_barrier
    s_add_u32 m0, s9, 0
    s_nop 0
    buffer_load_dwordx4 v18, s[48:51], s13 offen lds
    s_waitcnt vmcnt(13)
    s_barrier
    s_waitcnt vmcnt(9)
    s_barrier
    s_waitcnt vmcnt(5)
    s_barrier
    s_waitcnt vmcnt(1)
    s_barrier
    s_waitcnt vmcnt(0)
    s_barrier
    s_branch L_end
L_compute:
    v_and_b32 v3, 15, v2
    v_lshrrev_b32 v4, 4, v2
    s_lshl_b32 s6, s5, 4
    v_add_u32 v1, s6, v3
    v_lshlrev_b32 v15, 9, v1
    v_lshl_add_u32 v1, v4, 4, v15
    s_lshl_b32 s6, s3, 15
    s_lshr_b32 s7, s3, 3
    s_lshl_b32 s7, s7, 11
    s_lshl_b32 s8, s3, 17
    s_waitcnt lgkmcnt(0)
    s_add_u32 s36, s16, s6
    s_addc_u32 s37, s17, 0
    s_mov_b32 s38, 0x8000
    s_mov_b32 s39, 0x20000
    buffer_load_dwordx4 v[28:31], v1, s[36:39], 0 offen offset:0
    buffer_load_dwordx4 v[32:35], v1, s[36:39], 0 offen offset:64
    buffer_load_dwordx4 v[36:39], v1, s[36:39], 0 offen offset:128
    buffer_load_dwordx4 v[40:43], v1, s[36:39], 0 offen offset:192
    buffer_load_dwordx4 v[44:47], v1, s[36:39], 0 offen offset:256
    buffer_load_dwordx4 v[48:51], v1, s[36:39], 0 offen offset:320
    buffer_load_dwordx4 v[52:55], v1, s[36:39], 0 offen offset:384
    buffer_load_dwordx4 v[56:59], v1, s[36:39], 0 offen offset:448
    s_add_u32 s40, s26, s7
    s_addc_u32 s41, s27, 0
    s_mov_b32 s42, 0x800
    s_mov_b32 s43, 0x20000
    s_add_u32 s44, s28, s6
    s_addc_u32 s45, s29, 0
    s_mov_b32 s46, 0x8000
    s_mov_b32 s47, 0x20000
    s_add_u32 s48, s32, s8
    s_addc_u32 s49, s33, 0
    s_mov_b32 s50, 0x20000
    s_mov_b32 s51, 0x20000
    s_mov_b32 s52, s30
    s_mov_b32 s53, s31
    s_mov_b32 s54, 0x100
    s_mov_b32 s55, 0x20000
    v_add_u32 v15, 0, v4
    v_xor_b32 v15, v15, v3
    v_lshlrev_b32 v15, 4, v15
    v_lshl_add_u32 v16, v3, 9, v15
    v_add_u32 v15, 4, v4
    v_xor_b32 v15, v15, v3
    v_lshlrev_b32 v15, 4, v15
    v_lshl_add_u32 v17, v3, 9, v15
    v_add_u32 v15, 8, v4
    v_xor_b32 v15, v15, v3
    v_lshlrev_b32 v15, 4, v15
    v_lshl_add_u32 v18, v3, 9, v15
    v_add_u32 v15, 12, v4
    v_xor_b32 v15, v15, v3
    v_lshlrev_b32 v15, 4, v15
    v_lshl_add_u32 v19, v3, 9, v15
    v_lshrrev_b32 v15, 2, v3
    v_lshl_add_u32 v1, v4, 2, v15
    v_lshlrev_b32 v1, 7, v1
    v_and_b32 v0, 3, v3
    v_lshl_add_u32 v1, v0, 3, v1
    v_lshrrev_b32 v15, 1, v15
    v_lshl_add_u32 v15, v4, 1, v15
    v_and_b32 v15, 3, v15
    v_xor_b32 v0, 0, v15
    v_lshl_add_u32 v20, v0, 5, v1
    v_xor_b32 v0, 1, v15
    v_lshl_add_u32 v21, v0, 5, v1
    v_xor_b32 v0, 2, v15
    v_lshl_add_u32 v22, v0, 5, v1
    v_xor_b32 v0, 3, v15
    v_lshl_add_u32 v23, v0, 5, v1
    v_mov_b32 v15, 114688
    v_mov_b32 v1, 0
    ds_write_b32 v15, v1
    v_mov_b32 v244, 0xff800000
    s_mov_b32 s60, 0x3db8aa3b
    s_mov_b32 s61, 0xceabfb8f
    s_lshl_b32 s62, s5, 13
    s_xor_b32 s64, s4, 2
    s_lshl_b32 s65, s64, 15
    s_add_u32 s65, s65, s62
    s_add_u32 s66, s65, 4096
    s_lshl_b32 s67, s4, 15
    s_add_u32 s67, s67, s62
    s_add_u32 s68, s67, 4096
    s_lshl_b32 s74, s3, 2
    s_lshl_b32 s75, s4, 3
    s_lshl_b32 s71, s64, 3
    s_and_b32 s69, s5, 1
    s_lshl_b32 s69, s69, 10
    s_add_u32 s70, s62, s13
    s_waitcnt lgkmcnt(0)
    v_mov_b32 v8, 0x3f803f80
    v_mov_b32 v9, 0x3f803f80
    v_mov_b32 v10, 0x3f803f80
    v_mov_b32 v11, 0x3f803f80
    v_mov_b32 v24, v16
    v_mov_b32 v25, v17
    v_mov_b32 v26, v18
    v_mov_b32 v27, v19
    s_barrier
    ds_read_b128 v[220:223], v24 offset:0
    ds_read_b128 v[224:227], v25 offset:0
    ds_read_b128 v[228:231], v26 offset:0
    ds_read_b128 v[232:235], v27 offset:0
    ds_read_b128 v[236:239], v24 offset:256
    ds_read_b128 v[240:243], v25 offset:256
    ds_read_b128 v[0:3], v26 offset:256
    ds_read_b128 v[4:7], v27 offset:256
    s_waitcnt vmcnt(0)
    s_waitcnt lgkmcnt(6)
    v_mfma_f32_16x16x32_bf16 v[60:63], v[220:223], v[28:31], 0
    ds_read_b128 v[220:223], v24 offset:8192
    v_mfma_f32_16x16x32_bf16 v[60:63], v[224:227], v[32:35], v[60:63]
    ds_read_b128 v[224:227], v25 offset:8192
    s_waitcnt lgkmcnt(6)
    v_mfma_f32_16x16x32_bf16 v[60:63], v[228:231], v[36:39], v[60:63]
    ds_read_b128 v[228:231], v26 offset:8192
    v_mfma_f32_16x16x32_bf16 v[60:63], v[232:235], v[40:43], v[60:63]
    ds_read_b128 v[232:235], v27 offset:8192
    s_waitcnt lgkmcnt(6)
    v_mfma_f32_16x16x32_bf16 v[60:63], v[236:239], v[44:47], v[60:63]
    ds_read_b128 v[236:239], v24 offset:8448
    v_mfma_f32_16x16x32_bf16 v[60:63], v[240:243], v[48:51], v[60:63]
    ds_read_b128 v[240:243], v25 offset:8448
    s_waitcnt lgkmcnt(6)
    v_mfma_f32_16x16x32_bf16 v[60:63], v[0:3], v[52:55], v[60:63]
    ds_read_b128 v[0:3], v26 offset:8448
    v_mfma_f32_16x16x32_bf16 v[60:63], v[4:7], v[56:59], v[60:63]
    ds_read_b128 v[4:7], v27 offset:8448
    s_waitcnt lgkmcnt(6)
    v_mfma_f32_16x16x32_bf16 v[64:67], v[220:223], v[28:31], 0
    v_add_u32 v24, 16384, v16
    v_add_u32 v25, 16384, v17
    v_add_u32 v26, 16384, v18
    v_add_u32 v27, 16384, v19
    s_barrier
    ds_read_b128 v[220:223], v24 offset:0
    v_mfma_f32_16x16x32_bf16 v[64:67], v[224:227], v[32:35], v[64:67]
    ds_read_b128 v[224:227], v25 offset:0
    s_waitcnt lgkmcnt(6)
    v_mfma_f32_16x16x32_bf16 v[64:67], v[228:231], v[36:39], v[64:67]
    ds_read_b128 v[228:231], v26 offset:0
    v_mfma_f32_16x16x32_bf16 v[64:67], v[232:235], v[40:43], v[64:67]
    ds_read_b128 v[232:235], v27 offset:0
    s_waitcnt lgkmcnt(6)
    v_mfma_f32_16x16x32_bf16 v[64:67], v[236:239], v[44:47], v[64:67]
    ds_read_b128 v[236:239], v24 offset:256
    v_mfma_f32_16x16x32_bf16 v[64:67], v[240:243], v[48:51], v[64:67]
    ds_read_b128 v[240:243], v25 offset:256
    s_waitcnt lgkmcnt(6)
    v_mfma_f32_16x16x32_bf16 v[64:67], v[0:3], v[52:55], v[64:67]
    ds_read_b128 v[0:3], v26 offset:256
    v_mfma_f32_16x16x32_bf16 v[64:67], v[4:7], v[56:59], v[64:67]
    ds_read_b128 v[4:7], v27 offset:256
    s_waitcnt lgkmcnt(6)
    v_mfma_f32_16x16x32_bf16 v[68:71], v[220:223], v[28:31], 0
    ds_read_b128 v[220:223], v24 offset:8192
    v_mfma_f32_16x16x32_bf16 v[68:71], v[224:227], v[32:35], v[68:71]
    ds_read_b128 v[224:227], v25 offset:8192
    s_waitcnt lgkmcnt(6)
    v_mfma_f32_16x16x32_bf16 v[68:71], v[228:231], v[36:39], v[68:71]
    ds_read_b128 v[228:231], v26 offset:8192
    v_mfma_f32_16x16x32_bf16 v[68:71], v[232:235], v[40:43], v[68:71]
    ds_read_b128 v[232:235], v27 offset:8192
    s_waitcnt lgkmcnt(6)
    v_mfma_f32_16x16x32_bf16 v[68:71], v[236:239], v[44:47], v[68:71]
    ds_read_b128 v[236:239], v24 offset:8448
    v_mfma_f32_16x16x32_bf16 v[68:71], v[240:243], v[48:51], v[68:71]
    ds_read_b128 v[240:243], v25 offset:8448
    s_waitcnt lgkmcnt(6)
    v_mfma_f32_16x16x32_bf16 v[68:71], v[0:3], v[52:55], v[68:71]
    ds_read_b128 v[0:3], v26 offset:8448
    v_mfma_f32_16x16x32_bf16 v[68:71], v[4:7], v[56:59], v[68:71]
    ds_read_b128 v[4:7], v27 offset:8448
    s_waitcnt lgkmcnt(6)
    v_mfma_f32_16x16x32_bf16 v[72:75], v[220:223], v[28:31], 0
    v_add_u32 v24, 32768, v16
    v_add_u32 v25, 32768, v17
    v_add_u32 v26, 32768, v18
    v_add_u32 v27, 32768, v19
    s_barrier
    ds_read_b128 v[220:223], v24 offset:0
    v_mfma_f32_16x16x32_bf16 v[72:75], v[224:227], v[32:35], v[72:75]
    ds_read_b128 v[224:227], v25 offset:0
    s_waitcnt lgkmcnt(6)
    v_mfma_f32_16x16x32_bf16 v[72:75], v[228:231], v[36:39], v[72:75]
    ds_read_b128 v[228:231], v26 offset:0
    v_mfma_f32_16x16x32_bf16 v[72:75], v[232:235], v[40:43], v[72:75]
    ds_read_b128 v[232:235], v27 offset:0
    s_waitcnt lgkmcnt(6)
    v_mfma_f32_16x16x32_bf16 v[72:75], v[236:239], v[44:47], v[72:75]
    ds_read_b128 v[236:239], v24 offset:256
    v_mfma_f32_16x16x32_bf16 v[72:75], v[240:243], v[48:51], v[72:75]
    ds_read_b128 v[240:243], v25 offset:256
    s_waitcnt lgkmcnt(6)
    v_mfma_f32_16x16x32_bf16 v[72:75], v[0:3], v[52:55], v[72:75]
    ds_read_b128 v[0:3], v26 offset:256
    v_mfma_f32_16x16x32_bf16 v[72:75], v[4:7], v[56:59], v[72:75]
    ds_read_b128 v[4:7], v27 offset:256
    s_waitcnt lgkmcnt(6)
    v_mfma_f32_16x16x32_bf16 v[76:79], v[220:223], v[28:31], 0
    ds_read_b128 v[220:223], v24 offset:8192
    v_mfma_f32_16x16x32_bf16 v[76:79], v[224:227], v[32:35], v[76:79]
    ds_read_b128 v[224:227], v25 offset:8192
    s_waitcnt lgkmcnt(6)
    v_mfma_f32_16x16x32_bf16 v[76:79], v[228:231], v[36:39], v[76:79]
    ds_read_b128 v[228:231], v26 offset:8192
    v_mfma_f32_16x16x32_bf16 v[76:79], v[232:235], v[40:43], v[76:79]
    ds_read_b128 v[232:235], v27 offset:8192
    s_waitcnt lgkmcnt(6)
    v_mfma_f32_16x16x32_bf16 v[76:79], v[236:239], v[44:47], v[76:79]
    ds_read_b128 v[236:239], v24 offset:8448
    v_mfma_f32_16x16x32_bf16 v[76:79], v[240:243], v[48:51], v[76:79]
    ds_read_b128 v[240:243], v25 offset:8448
    s_waitcnt lgkmcnt(6)
    v_mfma_f32_16x16x32_bf16 v[76:79], v[0:3], v[52:55], v[76:79]
    ds_read_b128 v[0:3], v26 offset:8448
    v_mfma_f32_16x16x32_bf16 v[76:79], v[4:7], v[56:59], v[76:79]
    ds_read_b128 v[4:7], v27 offset:8448
    s_waitcnt lgkmcnt(6)
    v_mfma_f32_16x16x32_bf16 v[80:83], v[220:223], v[28:31], 0
    v_add_u32 v24, 49152, v16
    v_add_u32 v25, 49152, v17
    v_add_u32 v26, 49152, v18
    v_add_u32 v27, 49152, v19
    s_barrier
    ds_read_b128 v[220:223], v24 offset:0
    v_mfma_f32_16x16x32_bf16 v[80:83], v[224:227], v[32:35], v[80:83]
    ds_read_b128 v[224:227], v25 offset:0
    s_waitcnt lgkmcnt(6)
    v_mfma_f32_16x16x32_bf16 v[80:83], v[228:231], v[36:39], v[80:83]
    ds_read_b128 v[228:231], v26 offset:0
    v_mfma_f32_16x16x32_bf16 v[80:83], v[232:235], v[40:43], v[80:83]
    ds_read_b128 v[232:235], v27 offset:0
    s_waitcnt lgkmcnt(6)
    v_mfma_f32_16x16x32_bf16 v[80:83], v[236:239], v[44:47], v[80:83]
    ds_read_b128 v[236:239], v24 offset:256
    v_mfma_f32_16x16x32_bf16 v[80:83], v[240:243], v[48:51], v[80:83]
    ds_read_b128 v[240:243], v25 offset:256
    s_waitcnt lgkmcnt(6)
    v_mfma_f32_16x16x32_bf16 v[80:83], v[0:3], v[52:55], v[80:83]
    ds_read_b128 v[0:3], v26 offset:256
    v_mfma_f32_16x16x32_bf16 v[80:83], v[4:7], v[56:59], v[80:83]
    ds_read_b128 v[4:7], v27 offset:256
    s_waitcnt lgkmcnt(6)
    v_mfma_f32_16x16x32_bf16 v[84:87], v[220:223], v[28:31], 0
    ds_read_b128 v[220:223], v24 offset:8192
    v_mfma_f32_16x16x32_bf16 v[84:87], v[224:227], v[32:35], v[84:87]
    ds_read_b128 v[224:227], v25 offset:8192
    s_waitcnt lgkmcnt(6)
    v_mfma_f32_16x16x32_bf16 v[84:87], v[228:231], v[36:39], v[84:87]
    ds_read_b128 v[228:231], v26 offset:8192
    v_mfma_f32_16x16x32_bf16 v[84:87], v[232:235], v[40:43], v[84:87]
    ds_read_b128 v[232:235], v27 offset:8192
    s_waitcnt lgkmcnt(6)
    v_mfma_f32_16x16x32_bf16 v[84:87], v[236:239], v[44:47], v[84:87]
    ds_read_b128 v[236:239], v24 offset:8448
    v_mfma_f32_16x16x32_bf16 v[84:87], v[240:243], v[48:51], v[84:87]
    ds_read_b128 v[240:243], v25 offset:8448
    s_waitcnt lgkmcnt(6)
    v_mfma_f32_16x16x32_bf16 v[84:87], v[0:3], v[52:55], v[84:87]
    ds_read_b128 v[0:3], v26 offset:8448
    v_mfma_f32_16x16x32_bf16 v[84:87], v[4:7], v[56:59], v[84:87]
    ds_read_b128 v[4:7], v27 offset:8448
    s_waitcnt lgkmcnt(6)
    v_mfma_f32_16x16x32_bf16 v[88:91], v[220:223], v[28:31], 0
    v_add_u32 v24, 65536, v16
    v_add_u32 v25, 65536, v17
    v_add_u32 v26, 65536, v18
    v_add_u32 v27, 65536, v19
    s_barrier
    ds_read_b128 v[220:223], v24 offset:0
    v_mfma_f32_16x16x32_bf16 v[88:91], v[224:227], v[32:35], v[88:91]
    ds_read_b128 v[224:227], v25 offset:0
    s_waitcnt lgkmcnt(6)
    v_mfma_f32_16x16x32_bf16 v[88:91], v[228:231], v[36:39], v[88:91]
    ds_read_b128 v[228:231], v26 offset:0
    v_mfma_f32_16x16x32_bf16 v[88:91], v[232:235], v[40:43], v[88:91]
    ds_read_b128 v[232:235], v27 offset:0
    s_waitcnt lgkmcnt(6)
    v_mfma_f32_16x16x32_bf16 v[88:91], v[236:239], v[44:47], v[88:91]
    ds_read_b128 v[236:239], v24 offset:256
    v_mfma_f32_16x16x32_bf16 v[88:91], v[240:243], v[48:51], v[88:91]
    ds_read_b128 v[240:243], v25 offset:256
    s_waitcnt lgkmcnt(6)
    v_mfma_f32_16x16x32_bf16 v[88:91], v[0:3], v[52:55], v[88:91]
    ds_read_b128 v[0:3], v26 offset:256
    v_mfma_f32_16x16x32_bf16 v[88:91], v[4:7], v[56:59], v[88:91]
    v_max3_f32 v253, v60, v61, v62
    v_max3_f32 v253, v63, v64, v253
    v_max3_f32 v253, v65, v66, v253
    ds_read_b128 v[4:7], v27 offset:256
    s_waitcnt lgkmcnt(6)
    v_mfma_f32_16x16x32_bf16 v[92:95], v[220:223], v[28:31], 0
    v_max_f32 v253, v67, v253
    v_max3_f32 v253, v68, v69, v253
    v_max3_f32 v253, v70, v71, v253
    ds_read_b128 v[220:223], v24 offset:8192
    v_mfma_f32_16x16x32_bf16 v[92:95], v[224:227], v[32:35], v[92:95]
    v_max3_f32 v253, v72, v73, v253
    v_max3_f32 v253, v74, v75, v253
    v_max3_f32 v253, v76, v77, v253
    ds_read_b128 v[224:227], v25 offset:8192
    s_waitcnt lgkmcnt(6)
    v_mfma_f32_16x16x32_bf16 v[92:95], v[228:231], v[36:39], v[92:95]
    v_max3_f32 v253, v78, v79, v253
    v_max3_f32 v253, v80, v81, v253
    v_max3_f32 v253, v82, v83, v253
    ds_read_b128 v[228:231], v26 offset:8192
    v_mfma_f32_16x16x32_bf16 v[92:95], v[232:235], v[40:43], v[92:95]
    v_max3_f32 v253, v84, v85, v253
    v_max3_f32 v253, v86, v87, v253
    v_max3_f32 v253, v88, v89, v253
    ds_read_b128 v[232:235], v27 offset:8192
    s_waitcnt lgkmcnt(6)
    v_mfma_f32_16x16x32_bf16 v[92:95], v[236:239], v[44:47], v[92:95]
    v_max3_f32 v253, v90, v91, v253
    v_mul_f32 v253, s60, v253
    v_mov_b32 v254, v253
    ds_read_b128 v[236:239], v24 offset:8448
    v_mfma_f32_16x16x32_bf16 v[92:95], v[240:243], v[48:51], v[92:95]
    s_nop 1
    v_permlane16_swap_b32 v253, v254
    v_max_f32 v253, v253, v254
    ds_read_b128 v[240:243], v25 offset:8448
    s_waitcnt lgkmcnt(6)
    v_mfma_f32_16x16x32_bf16 v[92:95], v[0:3], v[52:55], v[92:95]
    v_mov_b32 v254, v253
    s_nop 1
    v_permlane32_swap_b32 v253, v254
    ds_read_b128 v[0:3], v26 offset:8448
    v_mfma_f32_16x16x32_bf16 v[92:95], v[4:7], v[56:59], v[92:95]
    v_max_f32 v253, v253, v254
    v_max_f32 v253, v253, v244
    v_sub_f32 v255, v244, v253
    ds_read_b128 v[4:7], v27 offset:8448
    s_waitcnt lgkmcnt(6)
    v_mfma_f32_16x16x32_bf16 v[96:99], v[220:223], v[28:31], 0
    v_exp_f32 v255, v255
    v_mov_b32 v244, v253
    v_fma_f32 v60, v60, s60, -v244
    v_add_u32 v24, 81920, v16
    v_add_u32 v25, 81920, v17
    v_add_u32 v26, 81920, v18
    v_add_u32 v27, 81920, v19
    s_barrier
    ds_read_b128 v[220:223], v24 offset:0
    v_mfma_f32_16x16x32_bf16 v[96:99], v[224:227], v[32:35], v[96:99]
    v_fma_f32 v61, v61, s60, -v244
    v_fma_f32 v62, v62, s60, -v244
    v_fma_f32 v63, v63, s60, -v244
    ds_read_b128 v[224:227], v25 offset:0
    s_waitcnt lgkmcnt(6)
    v_mfma_f32_16x16x32_bf16 v[96:99], v[228:231], v[36:39], v[96:99]
    v_fma_f32 v64, v64, s60, -v244
    v_fma_f32 v65, v65, s60, -v244
    v_fma_f32 v66, v66, s60, -v244
    ds_read_b128 v[228:231], v26 offset:0
    v_mfma_f32_16x16x32_bf16 v[96:99], v[232:235], v[40:43], v[96:99]
    v_fma_f32 v67, v67, s60, -v244
    v_exp_f32 v60, v60
    v_exp_f32 v61, v61
    ds_read_b128 v[232:235], v27 offset:0
    s_waitcnt lgkmcnt(6)
    v_mfma_f32_16x16x32_bf16 v[96:99], v[236:239], v[44:47], v[96:99]
    v_exp_f32 v62, v62
    v_exp_f32 v63, v63
    v_exp_f32 v64, v64
    ds_read_b128 v[236:239], v24 offset:256
    v_mfma_f32_16x16x32_bf16 v[96:99], v[240:243], v[48:51], v[96:99]
    v_exp_f32 v65, v65
    v_exp_f32 v66, v66
    v_exp_f32 v67, v67
    ds_read_b128 v[240:243], v25 offset:256
    s_waitcnt lgkmcnt(6)
    v_mfma_f32_16x16x32_bf16 v[96:99], v[0:3], v[52:55], v[96:99]
    v_cvt_pk_bf16_f32 v60, v60, v61
    v_cvt_pk_bf16_f32 v61, v62, v63
    v_cvt_pk_bf16_f32 v62, v64, v65
    ds_read_b128 v[0:3], v26 offset:256
    v_mfma_f32_16x16x32_bf16 v[96:99], v[4:7], v[56:59], v[96:99]
    v_cvt_pk_bf16_f32 v63, v66, v67
    v_fma_f32 v68, v68, s60, -v244
    v_fma_f32 v69, v69, s60, -v244
    ds_read_b128 v[4:7], v27 offset:256
    s_waitcnt lgkmcnt(6)
    v_mfma_f32_16x16x32_bf16 v[100:103], v[220:223], v[28:31], 0
    v_fma_f32 v70, v70, s60, -v244
    v_fma_f32 v71, v71, s60, -v244
    v_fma_f32 v72, v72, s60, -v244
    ds_read_b128 v[220:223], v24 offset:8192
    v_mfma_f32_16x16x32_bf16 v[100:103], v[224:227], v[32:35], v[100:103]
    v_fma_f32 v73, v73, s60, -v244
    v_fma_f32 v74, v74, s60, -v244
    v_fma_f32 v75, v75, s60, -v244
    ds_read_b128 v[224:227], v25 offset:8192
    s_waitcnt lgkmcnt(6)
    v_mfma_f32_16x16x32_bf16 v[100:103], v[228:231], v[36:39], v[100:103]
    v_exp_f32 v68, v68
    v_exp_f32 v69, v69
    v_exp_f32 v70, v70
    ds_read_b128 v[228:231], v26 offset:8192
    v_mfma_f32_16x16x32_bf16 v[100:103], v[232:235], v[40:43], v[100:103]
    v_exp_f32 v71, v71
    v_exp_f32 v72, v72
    v_exp_f32 v73, v73
    ds_read_b128 v[232:235], v27 offset:8192
    s_waitcnt lgkmcnt(6)
    v_mfma_f32_16x16x32_bf16 v[100:103], v[236:239], v[44:47], v[100:103]
    v_exp_f32 v74, v74
    v_exp_f32 v75, v75
    v_cvt_pk_bf16_f32 v64, v68, v69
    ds_read_b128 v[236:239], v24 offset:8448
    v_mfma_f32_16x16x32_bf16 v[100:103], v[240:243], v[48:51], v[100:103]
    v_cvt_pk_bf16_f32 v65, v70, v71
    v_cvt_pk_bf16_f32 v66, v72, v73
    v_cvt_pk_bf16_f32 v67, v74, v75
    ds_read_b128 v[240:243], v25 offset:8448
    s_waitcnt lgkmcnt(6)
    v_mfma_f32_16x16x32_bf16 v[100:103], v[0:3], v[52:55], v[100:103]
    v_fma_f32 v76, v76, s60, -v244
    v_fma_f32 v77, v77, s60, -v244
    v_fma_f32 v78, v78, s60, -v244
    ds_read_b128 v[0:3], v26 offset:8448
    v_mfma_f32_16x16x32_bf16 v[100:103], v[4:7], v[56:59], v[100:103]
    v_fma_f32 v79, v79, s60, -v244
    v_fma_f32 v80, v80, s60, -v244
    v_fma_f32 v81, v81, s60, -v244
    ds_read_b128 v[4:7], v27 offset:8448
    s_waitcnt lgkmcnt(6)
    v_mfma_f32_16x16x32_bf16 v[104:107], v[220:223], v[28:31], 0
    v_fma_f32 v82, v82, s60, -v244
    v_fma_f32 v83, v83, s60, -v244
    v_exp_f32 v76, v76
    v_add_u32 v24, 98304, v16
    v_add_u32 v25, 98304, v17
    v_add_u32 v26, 98304, v18
    v_add_u32 v27, 98304, v19
    s_barrier
    ds_read_b128 v[220:223], v24 offset:0
    v_mfma_f32_16x16x32_bf16 v[104:107], v[224:227], v[32:35], v[104:107]
    v_exp_f32 v77, v77
    v_exp_f32 v78, v78
    v_exp_f32 v79, v79
    ds_read_b128 v[224:227], v25 offset:0
    s_waitcnt lgkmcnt(6)
    v_mfma_f32_16x16x32_bf16 v[104:107], v[228:231], v[36:39], v[104:107]
    v_exp_f32 v80, v80
    v_exp_f32 v81, v81
    v_exp_f32 v82, v82
    ds_read_b128 v[228:231], v26 offset:0
    v_mfma_f32_16x16x32_bf16 v[104:107], v[232:235], v[40:43], v[104:107]
    v_exp_f32 v83, v83
    v_cvt_pk_bf16_f32 v68, v76, v77
    v_cvt_pk_bf16_f32 v69, v78, v79
    ds_read_b128 v[232:235], v27 offset:0
    s_waitcnt lgkmcnt(6)
    v_mfma_f32_16x16x32_bf16 v[104:107], v[236:239], v[44:47], v[104:107]
    v_cvt_pk_bf16_f32 v70, v80, v81
    v_cvt_pk_bf16_f32 v71, v82, v83
    v_fma_f32 v84, v84, s60, -v244
    ds_read_b128 v[236:239], v24 offset:256
    v_mfma_f32_16x16x32_bf16 v[104:107], v[240:243], v[48:51], v[104:107]
    v_fma_f32 v85, v85, s60, -v244
    v_fma_f32 v86, v86, s60, -v244
    v_fma_f32 v87, v87, s60, -v244
    ds_read_b128 v[240:243], v25 offset:256
    s_waitcnt lgkmcnt(6)
    v_mfma_f32_16x16x32_bf16 v[104:107], v[0:3], v[52:55], v[104:107]
    v_fma_f32 v88, v88, s60, -v244
    v_fma_f32 v89, v89, s60, -v244
    v_fma_f32 v90, v90, s60, -v244
    ds_read_b128 v[0:3], v26 offset:256
    v_mfma_f32_16x16x32_bf16 v[104:107], v[4:7], v[56:59], v[104:107]
    v_fma_f32 v91, v91, s60, -v244
    v_exp_f32 v84, v84
    v_exp_f32 v85, v85
    ds_read_b128 v[4:7], v27 offset:256
    s_waitcnt lgkmcnt(6)
    v_mfma_f32_16x16x32_bf16 v[108:111], v[220:223], v[28:31], 0
    v_exp_f32 v86, v86
    v_exp_f32 v87, v87
    v_exp_f32 v88, v88
    ds_read_b128 v[220:223], v24 offset:8192
    v_mfma_f32_16x16x32_bf16 v[108:111], v[224:227], v[32:35], v[108:111]
    v_exp_f32 v89, v89
    v_exp_f32 v90, v90
    v_exp_f32 v91, v91
    ds_read_b128 v[224:227], v25 offset:8192
    s_waitcnt lgkmcnt(6)
    v_mfma_f32_16x16x32_bf16 v[108:111], v[228:231], v[36:39], v[108:111]
    v_cvt_pk_bf16_f32 v72, v84, v85
    v_cvt_pk_bf16_f32 v73, v86, v87
    v_cvt_pk_bf16_f32 v74, v88, v89
    ds_read_b128 v[228:231], v26 offset:8192
    v_mfma_f32_16x16x32_bf16 v[108:111], v[232:235], v[40:43], v[108:111]
    v_cvt_pk_bf16_f32 v75, v90, v91
    ds_read_b128 v[232:235], v27 offset:8192
    s_waitcnt lgkmcnt(6)
    v_mfma_f32_16x16x32_bf16 v[108:111], v[236:239], v[44:47], v[108:111]
    ds_read_b128 v[236:239], v24 offset:8448
    v_mfma_f32_16x16x32_bf16 v[108:111], v[240:243], v[48:51], v[108:111]
    ds_read_b128 v[240:243], v25 offset:8448
    s_waitcnt lgkmcnt(6)
    v_mfma_f32_16x16x32_bf16 v[108:111], v[0:3], v[52:55], v[108:111]
    ds_read_b128 v[0:3], v26 offset:8448
    v_mfma_f32_16x16x32_bf16 v[108:111], v[4:7], v[56:59], v[108:111]
    ds_read_b128 v[4:7], v27 offset:8448
    s_waitcnt lgkmcnt(6)
    v_mfma_f32_16x16x32_bf16 v[112:115], v[220:223], v[28:31], 0
    v_mov_b32 v24, v16
    v_mov_b32 v25, v17
    v_mov_b32 v26, v18
    v_mov_b32 v27, v19
    s_barrier
    ds_read_b128 v[220:223], v24 offset:0
    v_mfma_f32_16x16x32_bf16 v[112:115], v[224:227], v[32:35], v[112:115]
    ds_read_b128 v[224:227], v25 offset:0
    s_waitcnt lgkmcnt(6)
    v_mfma_f32_16x16x32_bf16 v[112:115], v[228:231], v[36:39], v[112:115]
    ds_read_b128 v[228:231], v26 offset:0
    v_mfma_f32_16x16x32_bf16 v[112:115], v[232:235], v[40:43], v[112:115]
    ds_read_b128 v[232:235], v27 offset:0
    s_waitcnt lgkmcnt(6)
    v_mfma_f32_16x16x32_bf16 v[112:115], v[236:239], v[44:47], v[112:115]
    ds_read_b128 v[236:239], v24 offset:256
    v_mfma_f32_16x16x32_bf16 v[112:115], v[240:243], v[48:51], v[112:115]
    ds_read_b128 v[240:243], v25 offset:256
    s_waitcnt lgkmcnt(6)
    v_mfma_f32_16x16x32_bf16 v[112:115], v[0:3], v[52:55], v[112:115]
    ds_read_b128 v[0:3], v26 offset:256
    v_mfma_f32_16x16x32_bf16 v[112:115], v[4:7], v[56:59], v[112:115]
    ds_read_b128 v[4:7], v27 offset:256
    s_waitcnt lgkmcnt(6)
    v_mfma_f32_16x16x32_bf16 v[116:119], v[220:223], v[28:31], 0
    ds_read_b128 v[220:223], v24 offset:8192
    v_mfma_f32_16x16x32_bf16 v[116:119], v[224:227], v[32:35], v[116:119]
    ds_read_b128 v[224:227], v25 offset:8192
    s_waitcnt lgkmcnt(6)
    v_mfma_f32_16x16x32_bf16 v[116:119], v[228:231], v[36:39], v[116:119]
    ds_read_b128 v[228:231], v26 offset:8192
    v_mfma_f32_16x16x32_bf16 v[116:119], v[232:235], v[40:43], v[116:119]
    ds_read_b128 v[232:235], v27 offset:8192
    s_waitcnt lgkmcnt(6)
    v_mfma_f32_16x16x32_bf16 v[116:119], v[236:239], v[44:47], v[116:119]
    ds_read_b128 v[236:239], v24 offset:8448
    v_mfma_f32_16x16x32_bf16 v[116:119], v[240:243], v[48:51], v[116:119]
    ds_read_b128 v[240:243], v25 offset:8448
    s_waitcnt lgkmcnt(6)
    v_mfma_f32_16x16x32_bf16 v[116:119], v[0:3], v[52:55], v[116:119]
    ds_read_b128 v[0:3], v26 offset:8448
    v_mfma_f32_16x16x32_bf16 v[116:119], v[4:7], v[56:59], v[116:119]
    ds_read_b128 v[4:7], v27 offset:8448
    s_waitcnt lgkmcnt(6)
    v_mfma_f32_16x16x32_bf16 v[120:123], v[220:223], v[28:31], 0
    v_add_u32 v24, 16384, v20
    v_add_u32 v25, 16384, v21
    v_add_u32 v26, 16384, v22
    v_add_u32 v27, 16384, v23
    s_barrier
    ds_read_b64_tr_b16 v[220:221], v24 offset:0
    ds_read_b64_tr_b16 v[222:223], v24 offset:2048
    v_mfma_f32_16x16x32_bf16 v[120:123], v[224:227], v[32:35], v[120:123]
    ds_read_b64_tr_b16 v[224:225], v25 offset:0
    ds_read_b64_tr_b16 v[226:227], v25 offset:2048
    s_waitcnt lgkmcnt(8)
    v_mfma_f32_16x16x32_bf16 v[120:123], v[228:231], v[36:39], v[120:123]
    ds_read_b64_tr_b16 v[228:229], v26 offset:0
    ds_read_b64_tr_b16 v[230:231], v26 offset:2048
    v_mfma_f32_16x16x32_bf16 v[120:123], v[232:235], v[40:43], v[120:123]
    ds_read_b64_tr_b16 v[232:233], v27 offset:0
    ds_read_b64_tr_b16 v[234:235], v27 offset:2048
    s_waitcnt lgkmcnt(10)
    v_mfma_f32_16x16x32_bf16 v[120:123], v[236:239], v[44:47], v[120:123]
    ds_read_b64_tr_b16 v[236:237], v24 offset:4096
    ds_read_b64_tr_b16 v[238:239], v24 offset:6144
    v_mfma_f32_16x16x32_bf16 v[120:123], v[240:243], v[48:51], v[120:123]
    ds_read_b64_tr_b16 v[240:241], v25 offset:4096
    ds_read_b64_tr_b16 v[242:243], v25 offset:6144
    s_waitcnt lgkmcnt(12)
    v_mfma_f32_16x16x32_bf16 v[120:123], v[0:3], v[52:55], v[120:123]
    ds_read_b64_tr_b16 v[0:1], v26 offset:4096
    ds_read_b64_tr_b16 v[2:3], v26 offset:6144
    v_mfma_f32_16x16x32_bf16 v[120:123], v[4:7], v[56:59], v[120:123]
    v_max3_f32 v253, v92, v93, v94
    v_max3_f32 v253, v95, v96, v253
    v_max3_f32 v253, v97, v98, v253
    s_waitcnt lgkmcnt(10)
    v_mfma_f32_16x16x32_bf16 v[204:207], v[220:223], v[60:63], 0
    v_max_f32 v253, v99, v253
    v_max3_f32 v253, v100, v101, v253
    v_max3_f32 v253, v102, v103, v253
    ds_read_b64_tr_b16 v[4:5], v27 offset:4096
    ds_read_b64_tr_b16 v[6:7], v27 offset:6144
    ds_read_b64_tr_b16 v[220:221], v24 offset:8192
    ds_read_b64_tr_b16 v[222:223], v24 offset:10240
    v_mfma_f32_16x16x32_bf16 v[208:211], v[224:227], v[60:63], 0
    v_max3_f32 v253, v104, v105, v253
    v_max3_f32 v253, v106, v107, v253
    v_max3_f32 v253, v108, v109, v253
    s_waitcnt lgkmcnt(10)
    v_mfma_f32_16x16x32_bf16 v[212:215], v[228:231], v[60:63], 0
    v_max3_f32 v253, v110, v111, v253
    v_max3_f32 v253, v112, v113, v253
    v_max3_f32 v253, v114, v115, v253
    ds_read_b64_tr_b16 v[224:225], v25 offset:8192
    ds_read_b64_tr_b16 v[226:227], v25 offset:10240
    ds_read_b64_tr_b16 v[228:229], v26 offset:8192
    ds_read_b64_tr_b16 v[230:231], v26 offset:10240
    v_mfma_f32_16x16x32_bf16 v[216:219], v[232:235], v[60:63], 0
    v_mfma_f32_16x16x32_bf16 v[12:15], v[8:11], v[60:63], 0
    v_max3_f32 v253, v116, v117, v253
    v_max3_f32 v253, v118, v119, v253
    v_max3_f32 v253, v120, v121, v253
    s_waitcnt lgkmcnt(10)
    v_mfma_f32_16x16x32_bf16 v[204:207], v[236:239], v[64:67], v[204:207]
    v_max3_f32 v253, v122, v123, v253
    v_mul_f32 v253, s60, v253
    v_mov_b32 v254, v253
    ds_read_b64_tr_b16 v[232:233], v27 offset:8192
    ds_read_b64_tr_b16 v[234:235], v27 offset:10240
    ds_read_b64_tr_b16 v[236:237], v24 offset:12288
    ds_read_b64_tr_b16 v[238:239], v24 offset:14336
    v_mfma_f32_16x16x32_bf16 v[208:211], v[240:243], v[64:67], v[208:211]
    s_nop 1
    v_permlane16_swap_b32 v253, v254
    v_max_f32 v253, v253, v254
    s_waitcnt lgkmcnt(10)
    v_mfma_f32_16x16x32_bf16 v[212:215], v[0:3], v[64:67], v[212:215]
    v_mov_b32 v254, v253
    s_nop 1
    v_permlane32_swap_b32 v253, v254
    ds_read_b64_tr_b16 v[240:241], v25 offset:12288
    ds_read_b64_tr_b16 v[242:243], v25 offset:14336
    ds_read_b64_tr_b16 v[0:1], v26 offset:12288
    ds_read_b64_tr_b16 v[2:3], v26 offset:14336
    v_mfma_f32_16x16x32_bf16 v[216:219], v[4:7], v[64:67], v[216:219]
    v_mfma_f32_16x16x32_bf16 v[12:15], v[8:11], v[64:67], v[12:15]
    v_max_f32 v253, v253, v254
    v_max_f32 v253, v253, v244
    v_sub_f32 v246, v244, v253
    s_waitcnt lgkmcnt(10)
    v_mfma_f32_16x16x32_bf16 v[204:207], v[220:223], v[68:71], v[204:207]
    v_exp_f32 v246, v246
    v_mov_b32 v244, v253
    v_fma_f32 v92, v92, s60, -v244
    ds_read_b64_tr_b16 v[4:5], v27 offset:12288
    ds_read_b64_tr_b16 v[6:7], v27 offset:14336
    v_add_u32 v24, 32768, v16
    v_add_u32 v25, 32768, v17
    v_add_u32 v26, 32768, v18
    v_add_u32 v27, 32768, v19
    s_barrier
    ds_read_b128 v[220:223], v24 offset:0
    v_mfma_f32_16x16x32_bf16 v[208:211], v[224:227], v[68:71], v[208:211]
    v_fma_f32 v93, v93, s60, -v244
    v_fma_f32 v94, v94, s60, -v244
    v_fma_f32 v95, v95, s60, -v244
    ds_read_b128 v[224:227], v25 offset:0
    s_waitcnt lgkmcnt(10)
    v_mfma_f32_16x16x32_bf16 v[212:215], v[228:231], v[68:71], v[212:215]
    v_fma_f32 v96, v96, s60, -v244
    v_fma_f32 v97, v97, s60, -v244
    v_fma_f32 v98, v98, s60, -v244
    ds_read_b128 v[228:231], v26 offset:0
    v_mfma_f32_16x16x32_bf16 v[216:219], v[232:235], v[68:71], v[216:219]
    v_mfma_f32_16x16x32_bf16 v[12:15], v[8:11], v[68:71], v[12:15]
    v_fma_f32 v99, v99, s60, -v244
    v_exp_f32 v92, v92
    v_exp_f32 v93, v93
    ds_read_b128 v[232:235], v27 offset:0
    s_waitcnt lgkmcnt(8)
    v_mfma_f32_16x16x32_bf16 v[204:207], v[236:239], v[72:75], v[204:207]
    v_exp_f32 v94, v94
    v_exp_f32 v95, v95
    v_exp_f32 v96, v96
    ds_read_b128 v[236:239], v24 offset:256
    v_mfma_f32_16x16x32_bf16 v[208:211], v[240:243], v[72:75], v[208:211]
    v_exp_f32 v97, v97
    v_exp_f32 v98, v98
    v_exp_f32 v99, v99
    ds_read_b128 v[240:243], v25 offset:256
    s_waitcnt lgkmcnt(6)
    v_mfma_f32_16x16x32_bf16 v[212:215], v[0:3], v[72:75], v[212:215]
    v_cvt_pk_bf16_f32 v92, v92, v93
    v_cvt_pk_bf16_f32 v93, v94, v95
    v_cvt_pk_bf16_f32 v94, v96, v97
    ds_read_b128 v[0:3], v26 offset:256
    v_mfma_f32_16x16x32_bf16 v[216:219], v[4:7], v[72:75], v[216:219]
    v_mfma_f32_16x16x32_bf16 v[12:15], v[8:11], v[72:75], v[12:15]
    v_cvt_pk_bf16_f32 v95, v98, v99
    v_fma_f32 v100, v100, s60, -v244
    v_fma_f32 v101, v101, s60, -v244
    ds_read_b128 v[4:7], v27 offset:256
    s_waitcnt lgkmcnt(6)
    v_mfma_f32_16x16x32_bf16 v[76:79], v[220:223], v[28:31], 0
    v_fma_f32 v102, v102, s60, -v244
    v_fma_f32 v103, v103, s60, -v244
    v_fma_f32 v104, v104, s60, -v244
    ds_read_b128 v[220:223], v24 offset:8192
    v_mfma_f32_16x16x32_bf16 v[76:79], v[224:227], v[32:35], v[76:79]
    v_fma_f32 v105, v105, s60, -v244
    v_fma_f32 v106, v106, s60, -v244
    v_fma_f32 v107, v107, s60, -v244
    ds_read_b128 v[224:227], v25 offset:8192
    s_waitcnt lgkmcnt(6)
    v_mfma_f32_16x16x32_bf16 v[76:79], v[228:231], v[36:39], v[76:79]
    v_exp_f32 v100, v100
    v_exp_f32 v101, v101
    v_exp_f32 v102, v102
    ds_read_b128 v[228:231], v26 offset:8192
    v_mfma_f32_16x16x32_bf16 v[76:79], v[232:235], v[40:43], v[76:79]
    v_exp_f32 v103, v103
    v_exp_f32 v104, v104
    v_exp_f32 v105, v105
    ds_read_b128 v[232:235], v27 offset:8192
    s_waitcnt lgkmcnt(6)
    v_mfma_f32_16x16x32_bf16 v[76:79], v[236:239], v[44:47], v[76:79]
    v_exp_f32 v106, v106
    v_exp_f32 v107, v107
    v_cvt_pk_bf16_f32 v96, v100, v101
    ds_read_b128 v[236:239], v24 offset:8448
    v_mfma_f32_16x16x32_bf16 v[76:79], v[240:243], v[48:51], v[76:79]
    v_cvt_pk_bf16_f32 v97, v102, v103
    v_cvt_pk_bf16_f32 v98, v104, v105
    v_cvt_pk_bf16_f32 v99, v106, v107
    ds_read_b128 v[240:243], v25 offset:8448
    s_waitcnt lgkmcnt(6)
    v_mfma_f32_16x16x32_bf16 v[76:79], v[0:3], v[52:55], v[76:79]
    v_fma_f32 v108, v108, s60, -v244
    v_fma_f32 v109, v109, s60, -v244
    v_fma_f32 v110, v110, s60, -v244
    ds_read_b128 v[0:3], v26 offset:8448
    v_mfma_f32_16x16x32_bf16 v[76:79], v[4:7], v[56:59], v[76:79]
    v_fma_f32 v111, v111, s60, -v244
    v_fma_f32 v112, v112, s60, -v244
    v_fma_f32 v113, v113, s60, -v244
    ds_read_b128 v[4:7], v27 offset:8448
    s_waitcnt lgkmcnt(6)
    v_mfma_f32_16x16x32_bf16 v[80:83], v[220:223], v[28:31], 0
    v_fma_f32 v114, v114, s60, -v244
    v_fma_f32 v115, v115, s60, -v244
    v_exp_f32 v108, v108
    v_add_u32 v24, 49152, v16
    v_add_u32 v25, 49152, v17
    v_add_u32 v26, 49152, v18
    v_add_u32 v27, 49152, v19
    s_barrier
    ds_read_b128 v[220:223], v24 offset:0
    v_mfma_f32_16x16x32_bf16 v[80:83], v[224:227], v[32:35], v[80:83]
    v_exp_f32 v109, v109
    v_exp_f32 v110, v110
    v_exp_f32 v111, v111
    ds_read_b128 v[224:227], v25 offset:0
    s_waitcnt lgkmcnt(6)
    v_mfma_f32_16x16x32_bf16 v[80:83], v[228:231], v[36:39], v[80:83]
    v_exp_f32 v112, v112
    v_exp_f32 v113, v113
    v_exp_f32 v114, v114
    ds_read_b128 v[228:231], v26 offset:0
    v_mfma_f32_16x16x32_bf16 v[80:83], v[232:235], v[40:43], v[80:83]
    v_exp_f32 v115, v115
    v_cvt_pk_bf16_f32 v100, v108, v109
    v_cvt_pk_bf16_f32 v101, v110, v111
    ds_read_b128 v[232:235], v27 offset:0
    s_waitcnt lgkmcnt(6)
    v_mfma_f32_16x16x32_bf16 v[80:83], v[236:239], v[44:47], v[80:83]
    v_cvt_pk_bf16_f32 v102, v112, v113
    v_cvt_pk_bf16_f32 v103, v114, v115
    v_fma_f32 v116, v116, s60, -v244
    ds_read_b128 v[236:239], v24 offset:256
    v_mfma_f32_16x16x32_bf16 v[80:83], v[240:243], v[48:51], v[80:83]
    v_fma_f32 v117, v117, s60, -v244
    v_fma_f32 v118, v118, s60, -v244
    v_fma_f32 v119, v119, s60, -v244
    ds_read_b128 v[240:243], v25 offset:256
    s_waitcnt lgkmcnt(6)
    v_mfma_f32_16x16x32_bf16 v[80:83], v[0:3], v[52:55], v[80:83]
    v_fma_f32 v120, v120, s60, -v244
    v_fma_f32 v121, v121, s60, -v244
    v_fma_f32 v122, v122, s60, -v244
    ds_read_b128 v[0:3], v26 offset:256
    v_mfma_f32_16x16x32_bf16 v[80:83], v[4:7], v[56:59], v[80:83]
    v_fma_f32 v123, v123, s60, -v244
    v_exp_f32 v116, v116
    v_exp_f32 v117, v117
    ds_read_b128 v[4:7], v27 offset:256
    s_waitcnt lgkmcnt(6)
    v_mfma_f32_16x16x32_bf16 v[84:87], v[220:223], v[28:31], 0
    v_exp_f32 v118, v118
    v_exp_f32 v119, v119
    v_exp_f32 v120, v120
    ds_read_b128 v[220:223], v24 offset:8192
    v_mfma_f32_16x16x32_bf16 v[84:87], v[224:227], v[32:35], v[84:87]
    v_exp_f32 v121, v121
    v_exp_f32 v122, v122
    v_exp_f32 v123, v123
    ds_read_b128 v[224:227], v25 offset:8192
    s_waitcnt lgkmcnt(6)
    v_mfma_f32_16x16x32_bf16 v[84:87], v[228:231], v[36:39], v[84:87]
    v_cvt_pk_bf16_f32 v104, v116, v117
    v_cvt_pk_bf16_f32 v105, v118, v119
    v_cvt_pk_bf16_f32 v106, v120, v121
    ds_read_b128 v[228:231], v26 offset:8192
    v_mfma_f32_16x16x32_bf16 v[84:87], v[232:235], v[40:43], v[84:87]
    v_cvt_pk_bf16_f32 v107, v122, v123
    ds_read_b128 v[232:235], v27 offset:8192
    s_waitcnt lgkmcnt(6)
    v_mfma_f32_16x16x32_bf16 v[84:87], v[236:239], v[44:47], v[84:87]
    ds_read_b128 v[236:239], v24 offset:8448
    v_mfma_f32_16x16x32_bf16 v[84:87], v[240:243], v[48:51], v[84:87]
    ds_read_b128 v[240:243], v25 offset:8448
    s_waitcnt lgkmcnt(6)
    v_mfma_f32_16x16x32_bf16 v[84:87], v[0:3], v[52:55], v[84:87]
    ds_read_b128 v[0:3], v26 offset:8448
    v_mfma_f32_16x16x32_bf16 v[84:87], v[4:7], v[56:59], v[84:87]
    ds_read_b128 v[4:7], v27 offset:8448
    s_waitcnt lgkmcnt(6)
    v_mfma_f32_16x16x32_bf16 v[88:91], v[220:223], v[28:31], 0
    v_add_u32 v24, 65536, v16
    v_add_u32 v25, 65536, v17
    v_add_u32 v26, 65536, v18
    v_add_u32 v27, 65536, v19
    s_barrier
    ds_read_b128 v[220:223], v24 offset:0
    v_mfma_f32_16x16x32_bf16 v[88:91], v[224:227], v[32:35], v[88:91]
    ds_read_b128 v[224:227], v25 offset:0
    s_waitcnt lgkmcnt(6)
    v_mfma_f32_16x16x32_bf16 v[88:91], v[228:231], v[36:39], v[88:91]
    ds_read_b128 v[228:231], v26 offset:0
    v_mfma_f32_16x16x32_bf16 v[88:91], v[232:235], v[40:43], v[88:91]
    ds_read_b128 v[232:235], v27 offset:0
    s_waitcnt lgkmcnt(6)
    v_mfma_f32_16x16x32_bf16 v[88:91], v[236:239], v[44:47], v[88:91]
    ds_read_b128 v[236:239], v24 offset:256
    v_mfma_f32_16x16x32_bf16 v[88:91], v[240:243], v[48:51], v[88:91]
    ds_read_b128 v[240:243], v25 offset:256
    s_waitcnt lgkmcnt(6)
    v_mfma_f32_16x16x32_bf16 v[88:91], v[0:3], v[52:55], v[88:91]
    ds_read_b128 v[0:3], v26 offset:256
    v_mfma_f32_16x16x32_bf16 v[88:91], v[4:7], v[56:59], v[88:91]
    ds_read_b128 v[4:7], v27 offset:256
    s_waitcnt lgkmcnt(6)
    v_mfma_f32_16x16x32_bf16 v[124:127], v[220:223], v[28:31], 0
    ds_read_b128 v[220:223], v24 offset:8192
    v_mfma_f32_16x16x32_bf16 v[124:127], v[224:227], v[32:35], v[124:127]
    ds_read_b128 v[224:227], v25 offset:8192
    s_waitcnt lgkmcnt(6)
    v_mfma_f32_16x16x32_bf16 v[124:127], v[228:231], v[36:39], v[124:127]
    ds_read_b128 v[228:231], v26 offset:8192
    v_mfma_f32_16x16x32_bf16 v[124:127], v[232:235], v[40:43], v[124:127]
    ds_read_b128 v[232:235], v27 offset:8192
    s_waitcnt lgkmcnt(6)
    v_mfma_f32_16x16x32_bf16 v[124:127], v[236:239], v[44:47], v[124:127]
    ds_read_b128 v[236:239], v24 offset:8448
    v_mfma_f32_16x16x32_bf16 v[124:127], v[240:243], v[48:51], v[124:127]
    ds_read_b128 v[240:243], v25 offset:8448
    s_waitcnt lgkmcnt(6)
    v_mfma_f32_16x16x32_bf16 v[124:127], v[0:3], v[52:55], v[124:127]
    ds_read_b128 v[0:3], v26 offset:8448
    v_mfma_f32_16x16x32_bf16 v[124:127], v[4:7], v[56:59], v[124:127]
    ds_read_b128 v[4:7], v27 offset:8448
    s_waitcnt lgkmcnt(6)
    v_mfma_f32_16x16x32_bf16 v[128:131], v[220:223], v[28:31], 0
    v_add_u32 v24, 81920, v16
    v_add_u32 v25, 81920, v17
    v_add_u32 v26, 81920, v18
    v_add_u32 v27, 81920, v19
    s_barrier
    ds_read_b128 v[220:223], v24 offset:0
    v_mfma_f32_16x16x32_bf16 v[128:131], v[224:227], v[32:35], v[128:131]
    ds_read_b128 v[224:227], v25 offset:0
    s_waitcnt lgkmcnt(6)
    v_mfma_f32_16x16x32_bf16 v[128:131], v[228:231], v[36:39], v[128:131]
    ds_read_b128 v[228:231], v26 offset:0
    v_mfma_f32_16x16x32_bf16 v[128:131], v[232:235], v[40:43], v[128:131]
    ds_read_b128 v[232:235], v27 offset:0
    s_waitcnt lgkmcnt(6)
    v_mfma_f32_16x16x32_bf16 v[128:131], v[236:239], v[44:47], v[128:131]
    ds_read_b128 v[236:239], v24 offset:256
    v_mfma_f32_16x16x32_bf16 v[128:131], v[240:243], v[48:51], v[128:131]
    ds_read_b128 v[240:243], v25 offset:256
    s_waitcnt lgkmcnt(6)
    v_mfma_f32_16x16x32_bf16 v[128:131], v[0:3], v[52:55], v[128:131]
    ds_read_b128 v[0:3], v26 offset:256
    v_mfma_f32_16x16x32_bf16 v[128:131], v[4:7], v[56:59], v[128:131]
    ds_read_b128 v[4:7], v27 offset:256
    s_waitcnt lgkmcnt(6)
    v_mfma_f32_16x16x32_bf16 v[132:135], v[220:223], v[28:31], 0
    ds_read_b128 v[220:223], v24 offset:8192
    v_mfma_f32_16x16x32_bf16 v[132:135], v[224:227], v[32:35], v[132:135]
    ds_read_b128 v[224:227], v25 offset:8192
    s_waitcnt lgkmcnt(6)
    v_mfma_f32_16x16x32_bf16 v[132:135], v[228:231], v[36:39], v[132:135]
    ds_read_b128 v[228:231], v26 offset:8192
    v_mfma_f32_16x16x32_bf16 v[132:135], v[232:235], v[40:43], v[132:135]
    ds_read_b128 v[232:235], v27 offset:8192
    s_waitcnt lgkmcnt(6)
    v_mfma_f32_16x16x32_bf16 v[132:135], v[236:239], v[44:47], v[132:135]
    ds_read_b128 v[236:239], v24 offset:8448
    v_mfma_f32_16x16x32_bf16 v[132:135], v[240:243], v[48:51], v[132:135]
    ds_read_b128 v[240:243], v25 offset:8448
    s_waitcnt lgkmcnt(6)
    v_mfma_f32_16x16x32_bf16 v[132:135], v[0:3], v[52:55], v[132:135]
    ds_read_b128 v[0:3], v26 offset:8448
    v_mfma_f32_16x16x32_bf16 v[132:135], v[4:7], v[56:59], v[132:135]
    ds_read_b128 v[4:7], v27 offset:8448
    s_waitcnt lgkmcnt(6)
    v_mfma_f32_16x16x32_bf16 v[136:139], v[220:223], v[28:31], 0
    v_add_u32 v24, 98304, v20
    v_add_u32 v25, 98304, v21
    v_add_u32 v26, 98304, v22
    v_add_u32 v27, 98304, v23
    s_barrier
    ds_read_b64_tr_b16 v[220:221], v24 offset:0
    ds_read_b64_tr_b16 v[222:223], v24 offset:2048
    v_mfma_f32_16x16x32_bf16 v[136:139], v[224:227], v[32:35], v[136:139]
    ds_read_b64_tr_b16 v[224:225], v25 offset:0
    ds_read_b64_tr_b16 v[226:227], v25 offset:2048
    s_waitcnt lgkmcnt(8)
    v_mfma_f32_16x16x32_bf16 v[136:139], v[228:231], v[36:39], v[136:139]
    ds_read_b64_tr_b16 v[228:229], v26 offset:0
    ds_read_b64_tr_b16 v[230:231], v26 offset:2048
    v_mfma_f32_16x16x32_bf16 v[136:139], v[232:235], v[40:43], v[136:139]
    ds_read_b64_tr_b16 v[232:233], v27 offset:0
    ds_read_b64_tr_b16 v[234:235], v27 offset:2048
    s_waitcnt lgkmcnt(10)
    v_mfma_f32_16x16x32_bf16 v[136:139], v[236:239], v[44:47], v[136:139]
    ds_read_b64_tr_b16 v[236:237], v24 offset:4096
    ds_read_b64_tr_b16 v[238:239], v24 offset:6144
    v_mfma_f32_16x16x32_bf16 v[136:139], v[240:243], v[48:51], v[136:139]
    ds_read_b64_tr_b16 v[240:241], v25 offset:4096
    ds_read_b64_tr_b16 v[242:243], v25 offset:6144
    s_waitcnt lgkmcnt(12)
    v_mfma_f32_16x16x32_bf16 v[136:139], v[0:3], v[52:55], v[136:139]
    ds_read_b64_tr_b16 v[0:1], v26 offset:4096
    ds_read_b64_tr_b16 v[2:3], v26 offset:6144
    v_mfma_f32_16x16x32_bf16 v[136:139], v[4:7], v[56:59], v[136:139]
    v_max3_f32 v253, v76, v77, v78
    v_max3_f32 v253, v79, v80, v253
    v_max3_f32 v253, v81, v82, v253
    s_nop 7
    v_mul_f32 v204, v204, v246
    v_mul_f32 v205, v205, v246
    v_mul_f32 v206, v206, v246
    v_mul_f32 v207, v207, v246
    v_mul_f32 v208, v208, v246
    v_mul_f32 v209, v209, v246
    v_mul_f32 v210, v210, v246
    v_mul_f32 v211, v211, v246
    v_mul_f32 v212, v212, v246
    v_mul_f32 v213, v213, v246
    v_mul_f32 v214, v214, v246
    v_mul_f32 v215, v215, v246
    v_mul_f32 v216, v216, v246
    v_mul_f32 v217, v217, v246
    v_mul_f32 v218, v218, v246
    v_mul_f32 v219, v219, v246
    v_mul_f32 v12, v12, v246
    v_mul_f32 v13, v13, v246
    v_mul_f32 v14, v14, v246
    v_mul_f32 v15, v15, v246
    s_nop 0
    s_waitcnt lgkmcnt(10)
    v_mfma_f32_16x16x32_bf16 v[204:207], v[220:223], v[92:95], v[204:207]
    v_max_f32 v253, v83, v253
    v_max3_f32 v253, v84, v85, v253
    v_max3_f32 v253, v86, v87, v253
    ds_read_b64_tr_b16 v[4:5], v27 offset:4096
    ds_read_b64_tr_b16 v[6:7], v27 offset:6144
    ds_read_b64_tr_b16 v[220:221], v24 offset:8192
    ds_read_b64_tr_b16 v[222:223], v24 offset:10240
    v_mfma_f32_16x16x32_bf16 v[208:211], v[224:227], v[92:95], v[208:211]
    v_max3_f32 v253, v88, v89, v253
    v_max3_f32 v253, v90, v91, v253
    v_max3_f32 v253, v124, v125, v253
    s_waitcnt lgkmcnt(10)
    v_mfma_f32_16x16x32_bf16 v[212:215], v[228:231], v[92:95], v[212:215]
    v_max3_f32 v253, v126, v127, v253
    v_max3_f32 v253, v128, v129, v253
    v_max3_f32 v253, v130, v131, v253
    ds_read_b64_tr_b16 v[224:225], v25 offset:8192
    ds_read_b64_tr_b16 v[226:227], v25 offset:10240
    ds_read_b64_tr_b16 v[228:229], v26 offset:8192
    ds_read_b64_tr_b16 v[230:231], v26 offset:10240
    v_mfma_f32_16x16x32_bf16 v[216:219], v[232:235], v[92:95], v[216:219]
    v_mfma_f32_16x16x32_bf16 v[12:15], v[8:11], v[92:95], v[12:15]
    v_max3_f32 v253, v132, v133, v253
    v_max3_f32 v253, v134, v135, v253
    v_max3_f32 v253, v136, v137, v253
    s_waitcnt lgkmcnt(10)
    v_mfma_f32_16x16x32_bf16 v[204:207], v[236:239], v[96:99], v[204:207]
    v_max3_f32 v253, v138, v139, v253
    v_mul_f32 v253, s60, v253
    v_mov_b32 v254, v253
    ds_read_b64_tr_b16 v[232:233], v27 offset:8192
    ds_read_b64_tr_b16 v[234:235], v27 offset:10240
    ds_read_b64_tr_b16 v[236:237], v24 offset:12288
    ds_read_b64_tr_b16 v[238:239], v24 offset:14336
    v_mfma_f32_16x16x32_bf16 v[208:211], v[240:243], v[96:99], v[208:211]
    s_nop 1
    v_permlane16_swap_b32 v253, v254
    v_max_f32 v253, v253, v254
    s_waitcnt lgkmcnt(10)
    v_mfma_f32_16x16x32_bf16 v[212:215], v[0:3], v[96:99], v[212:215]
    v_mov_b32 v254, v253
    s_nop 1
    v_permlane32_swap_b32 v253, v254
    ds_read_b64_tr_b16 v[240:241], v25 offset:12288
    ds_read_b64_tr_b16 v[242:243], v25 offset:14336
    ds_read_b64_tr_b16 v[0:1], v26 offset:12288
    ds_read_b64_tr_b16 v[2:3], v26 offset:14336
    v_mfma_f32_16x16x32_bf16 v[216:219], v[4:7], v[96:99], v[216:219]
    v_mfma_f32_16x16x32_bf16 v[12:15], v[8:11], v[96:99], v[12:15]
    v_max_f32 v253, v253, v254
    v_max_f32 v253, v253, v244
    v_sub_f32 v247, v244, v253
    s_waitcnt lgkmcnt(10)
    v_mfma_f32_16x16x32_bf16 v[204:207], v[220:223], v[100:103], v[204:207]
    v_exp_f32 v247, v247
    v_mov_b32 v244, v253
    v_fma_f32 v76, v76, s60, -v244
    ds_read_b64_tr_b16 v[4:5], v27 offset:12288
    ds_read_b64_tr_b16 v[6:7], v27 offset:14336
    v_mov_b32 v24, v16
    v_mov_b32 v25, v17
    v_mov_b32 v26, v18
    v_mov_b32 v27, v19
    s_barrier
    ds_read_b128 v[220:223], v24 offset:0
    v_mfma_f32_16x16x32_bf16 v[208:211], v[224:227], v[100:103], v[208:211]
    v_fma_f32 v77, v77, s60, -v244
    v_fma_f32 v78, v78, s60, -v244
    v_fma_f32 v79, v79, s60, -v244
    ds_read_b128 v[224:227], v25 offset:0
    s_waitcnt lgkmcnt(10)
    v_mfma_f32_16x16x32_bf16 v[212:215], v[228:231], v[100:103], v[212:215]
    v_fma_f32 v80, v80, s60, -v244
    v_fma_f32 v81, v81, s60, -v244
    v_fma_f32 v82, v82, s60, -v244
    ds_read_b128 v[228:231], v26 offset:0
    v_mfma_f32_16x16x32_bf16 v[216:219], v[232:235], v[100:103], v[216:219]
    v_mfma_f32_16x16x32_bf16 v[12:15], v[8:11], v[100:103], v[12:15]
    v_fma_f32 v83, v83, s60, -v244
    v_exp_f32 v76, v76
    v_exp_f32 v77, v77
    ds_read_b128 v[232:235], v27 offset:0
    s_waitcnt lgkmcnt(8)
    v_mfma_f32_16x16x32_bf16 v[204:207], v[236:239], v[104:107], v[204:207]
    v_exp_f32 v78, v78
    v_exp_f32 v79, v79
    v_exp_f32 v80, v80
    ds_read_b128 v[236:239], v24 offset:256
    v_mfma_f32_16x16x32_bf16 v[208:211], v[240:243], v[104:107], v[208:211]
    v_exp_f32 v81, v81
    v_exp_f32 v82, v82
    v_exp_f32 v83, v83
    ds_read_b128 v[240:243], v25 offset:256
    s_waitcnt lgkmcnt(6)
    v_mfma_f32_16x16x32_bf16 v[212:215], v[0:3], v[104:107], v[212:215]
    v_cvt_pk_bf16_f32 v76, v76, v77
    v_cvt_pk_bf16_f32 v77, v78, v79
    v_cvt_pk_bf16_f32 v78, v80, v81
    ds_read_b128 v[0:3], v26 offset:256
    v_mfma_f32_16x16x32_bf16 v[216:219], v[4:7], v[104:107], v[216:219]
    v_mfma_f32_16x16x32_bf16 v[12:15], v[8:11], v[104:107], v[12:15]
    v_cvt_pk_bf16_f32 v79, v82, v83
    v_fma_f32 v84, v84, s60, -v244
    v_fma_f32 v85, v85, s60, -v244
    ds_read_b128 v[4:7], v27 offset:256
    s_waitcnt lgkmcnt(6)
    v_mfma_f32_16x16x32_bf16 v[108:111], v[220:223], v[28:31], 0
    v_fma_f32 v86, v86, s60, -v244
    v_fma_f32 v87, v87, s60, -v244
    v_fma_f32 v88, v88, s60, -v244
    ds_read_b128 v[220:223], v24 offset:8192
    v_mfma_f32_16x16x32_bf16 v[108:111], v[224:227], v[32:35], v[108:111]
    v_fma_f32 v89, v89, s60, -v244
    v_fma_f32 v90, v90, s60, -v244
    v_fma_f32 v91, v91, s60, -v244
    ds_read_b128 v[224:227], v25 offset:8192
    s_waitcnt lgkmcnt(6)
    v_mfma_f32_16x16x32_bf16 v[108:111], v[228:231], v[36:39], v[108:111]
    v_exp_f32 v84, v84
    v_exp_f32 v85, v85
    v_exp_f32 v86, v86
    ds_read_b128 v[228:231], v26 offset:8192
    v_mfma_f32_16x16x32_bf16 v[108:111], v[232:235], v[40:43], v[108:111]
    v_exp_f32 v87, v87
    v_exp_f32 v88, v88
    v_exp_f32 v89, v89
    ds_read_b128 v[232:235], v27 offset:8192
    s_waitcnt lgkmcnt(6)
    v_mfma_f32_16x16x32_bf16 v[108:111], v[236:239], v[44:47], v[108:111]
    v_exp_f32 v90, v90
    v_exp_f32 v91, v91
    v_cvt_pk_bf16_f32 v80, v84, v85
    ds_read_b128 v[236:239], v24 offset:8448
    v_mfma_f32_16x16x32_bf16 v[108:111], v[240:243], v[48:51], v[108:111]
    v_cvt_pk_bf16_f32 v81, v86, v87
    v_cvt_pk_bf16_f32 v82, v88, v89
    v_cvt_pk_bf16_f32 v83, v90, v91
    ds_read_b128 v[240:243], v25 offset:8448
    s_waitcnt lgkmcnt(6)
    v_mfma_f32_16x16x32_bf16 v[108:111], v[0:3], v[52:55], v[108:111]
    v_fma_f32 v124, v124, s60, -v244
    v_fma_f32 v125, v125, s60, -v244
    v_fma_f32 v126, v126, s60, -v244
    ds_read_b128 v[0:3], v26 offset:8448
    v_mfma_f32_16x16x32_bf16 v[108:111], v[4:7], v[56:59], v[108:111]
    v_fma_f32 v127, v127, s60, -v244
    v_fma_f32 v128, v128, s60, -v244
    v_fma_f32 v129, v129, s60, -v244
    ds_read_b128 v[4:7], v27 offset:8448
    s_waitcnt lgkmcnt(6)
    v_mfma_f32_16x16x32_bf16 v[112:115], v[220:223], v[28:31], 0
    v_fma_f32 v130, v130, s60, -v244
    v_fma_f32 v131, v131, s60, -v244
    v_exp_f32 v124, v124
    v_add_u32 v24, 16384, v16
    v_add_u32 v25, 16384, v17
    v_add_u32 v26, 16384, v18
    v_add_u32 v27, 16384, v19
    s_barrier
    ds_read_b128 v[220:223], v24 offset:0
    v_mfma_f32_16x16x32_bf16 v[112:115], v[224:227], v[32:35], v[112:115]
    v_exp_f32 v125, v125
    v_exp_f32 v126, v126
    v_exp_f32 v127, v127
    ds_read_b128 v[224:227], v25 offset:0
    s_waitcnt lgkmcnt(6)
    v_mfma_f32_16x16x32_bf16 v[112:115], v[228:231], v[36:39], v[112:115]
    v_exp_f32 v128, v128
    v_exp_f32 v129, v129
    v_exp_f32 v130, v130
    ds_read_b128 v[228:231], v26 offset:0
    v_mfma_f32_16x16x32_bf16 v[112:115], v[232:235], v[40:43], v[112:115]
    v_exp_f32 v131, v131
    v_cvt_pk_bf16_f32 v84, v124, v125
    v_cvt_pk_bf16_f32 v85, v126, v127
    ds_read_b128 v[232:235], v27 offset:0
    s_waitcnt lgkmcnt(6)
    v_mfma_f32_16x16x32_bf16 v[112:115], v[236:239], v[44:47], v[112:115]
    v_cvt_pk_bf16_f32 v86, v128, v129
    v_cvt_pk_bf16_f32 v87, v130, v131
    v_fma_f32 v132, v132, s60, -v244
    ds_read_b128 v[236:239], v24 offset:256
    v_mfma_f32_16x16x32_bf16 v[112:115], v[240:243], v[48:51], v[112:115]
    v_fma_f32 v133, v133, s60, -v244
    v_fma_f32 v134, v134, s60, -v244
    v_fma_f32 v135, v135, s60, -v244
    ds_read_b128 v[240:243], v25 offset:256
    s_waitcnt lgkmcnt(6)
    v_mfma_f32_16x16x32_bf16 v[112:115], v[0:3], v[52:55], v[112:115]
    v_fma_f32 v136, v136, s60, -v244
    v_fma_f32 v137, v137, s60, -v244
    v_fma_f32 v138, v138, s60, -v244
    ds_read_b128 v[0:3], v26 offset:256
    v_mfma_f32_16x16x32_bf16 v[112:115], v[4:7], v[56:59], v[112:115]
    v_fma_f32 v139, v139, s60, -v244
    v_exp_f32 v132, v132
    v_exp_f32 v133, v133
    ds_read_b128 v[4:7], v27 offset:256
    s_waitcnt lgkmcnt(6)
    v_mfma_f32_16x16x32_bf16 v[116:119], v[220:223], v[28:31], 0
    v_exp_f32 v134, v134
    v_exp_f32 v135, v135
    v_exp_f32 v136, v136
    ds_read_b128 v[220:223], v24 offset:8192
    v_mfma_f32_16x16x32_bf16 v[116:119], v[224:227], v[32:35], v[116:119]
    v_exp_f32 v137, v137
    v_exp_f32 v138, v138
    v_exp_f32 v139, v139
    ds_read_b128 v[224:227], v25 offset:8192
    s_waitcnt lgkmcnt(6)
    v_mfma_f32_16x16x32_bf16 v[116:119], v[228:231], v[36:39], v[116:119]
    v_cvt_pk_bf16_f32 v88, v132, v133
    v_cvt_pk_bf16_f32 v89, v134, v135
    v_cvt_pk_bf16_f32 v90, v136, v137
    ds_read_b128 v[228:231], v26 offset:8192
    v_mfma_f32_16x16x32_bf16 v[116:119], v[232:235], v[40:43], v[116:119]
    v_cvt_pk_bf16_f32 v91, v138, v139
    ds_read_b128 v[232:235], v27 offset:8192
    s_waitcnt lgkmcnt(6)
    v_mfma_f32_16x16x32_bf16 v[116:119], v[236:239], v[44:47], v[116:119]
    ds_read_b128 v[236:239], v24 offset:8448
    v_mfma_f32_16x16x32_bf16 v[116:119], v[240:243], v[48:51], v[116:119]
    ds_read_b128 v[240:243], v25 offset:8448
    s_waitcnt lgkmcnt(6)
    v_mfma_f32_16x16x32_bf16 v[116:119], v[0:3], v[52:55], v[116:119]
    ds_read_b128 v[0:3], v26 offset:8448
    v_mfma_f32_16x16x32_bf16 v[116:119], v[4:7], v[56:59], v[116:119]
    ds_read_b128 v[4:7], v27 offset:8448
    s_waitcnt lgkmcnt(6)
    v_mfma_f32_16x16x32_bf16 v[120:123], v[220:223], v[28:31], 0
    v_add_u32 v24, 32768, v16
    v_add_u32 v25, 32768, v17
    v_add_u32 v26, 32768, v18
    v_add_u32 v27, 32768, v19
    s_barrier
    ds_read_b128 v[220:223], v24 offset:0
    v_mfma_f32_16x16x32_bf16 v[120:123], v[224:227], v[32:35], v[120:123]
    ds_read_b128 v[224:227], v25 offset:0
    s_waitcnt lgkmcnt(6)
    v_mfma_f32_16x16x32_bf16 v[120:123], v[228:231], v[36:39], v[120:123]
    ds_read_b128 v[228:231], v26 offset:0
    v_mfma_f32_16x16x32_bf16 v[120:123], v[232:235], v[40:43], v[120:123]
    ds_read_b128 v[232:235], v27 offset:0
    s_waitcnt lgkmcnt(6)
    v_mfma_f32_16x16x32_bf16 v[120:123], v[236:239], v[44:47], v[120:123]
    ds_read_b128 v[236:239], v24 offset:256
    v_mfma_f32_16x16x32_bf16 v[120:123], v[240:243], v[48:51], v[120:123]
    ds_read_b128 v[240:243], v25 offset:256
    s_waitcnt lgkmcnt(6)
    v_mfma_f32_16x16x32_bf16 v[120:123], v[0:3], v[52:55], v[120:123]
    ds_read_b128 v[0:3], v26 offset:256
    v_mfma_f32_16x16x32_bf16 v[120:123], v[4:7], v[56:59], v[120:123]
    ds_read_b128 v[4:7], v27 offset:256
    s_waitcnt lgkmcnt(6)
    v_mfma_f32_16x16x32_bf16 v[140:143], v[220:223], v[28:31], 0
    ds_read_b128 v[220:223], v24 offset:8192
    v_mfma_f32_16x16x32_bf16 v[140:143], v[224:227], v[32:35], v[140:143]
    ds_read_b128 v[224:227], v25 offset:8192
    s_waitcnt lgkmcnt(6)
    v_mfma_f32_16x16x32_bf16 v[140:143], v[228:231], v[36:39], v[140:143]
    ds_read_b128 v[228:231], v26 offset:8192
    v_mfma_f32_16x16x32_bf16 v[140:143], v[232:235], v[40:43], v[140:143]
    ds_read_b128 v[232:235], v27 offset:8192
    s_waitcnt lgkmcnt(6)
    v_mfma_f32_16x16x32_bf16 v[140:143], v[236:239], v[44:47], v[140:143]
    ds_read_b128 v[236:239], v24 offset:8448
    v_mfma_f32_16x16x32_bf16 v[140:143], v[240:243], v[48:51], v[140:143]
    ds_read_b128 v[240:243], v25 offset:8448
    s_waitcnt lgkmcnt(6)
    v_mfma_f32_16x16x32_bf16 v[140:143], v[0:3], v[52:55], v[140:143]
    ds_read_b128 v[0:3], v26 offset:8448
    v_mfma_f32_16x16x32_bf16 v[140:143], v[4:7], v[56:59], v[140:143]
    ds_read_b128 v[4:7], v27 offset:8448
    s_waitcnt lgkmcnt(6)
    v_mfma_f32_16x16x32_bf16 v[144:147], v[220:223], v[28:31], 0
    v_add_u32 v24, 49152, v16
    v_add_u32 v25, 49152, v17
    v_add_u32 v26, 49152, v18
    v_add_u32 v27, 49152, v19
    s_barrier
    ds_read_b128 v[220:223], v24 offset:0
    v_mfma_f32_16x16x32_bf16 v[144:147], v[224:227], v[32:35], v[144:147]
    ds_read_b128 v[224:227], v25 offset:0
    s_waitcnt lgkmcnt(6)
    v_mfma_f32_16x16x32_bf16 v[144:147], v[228:231], v[36:39], v[144:147]
    ds_read_b128 v[228:231], v26 offset:0
    v_mfma_f32_16x16x32_bf16 v[144:147], v[232:235], v[40:43], v[144:147]
    ds_read_b128 v[232:235], v27 offset:0
    s_waitcnt lgkmcnt(6)
    v_mfma_f32_16x16x32_bf16 v[144:147], v[236:239], v[44:47], v[144:147]
    ds_read_b128 v[236:239], v24 offset:256
    v_mfma_f32_16x16x32_bf16 v[144:147], v[240:243], v[48:51], v[144:147]
    ds_read_b128 v[240:243], v25 offset:256
    s_waitcnt lgkmcnt(6)
    v_mfma_f32_16x16x32_bf16 v[144:147], v[0:3], v[52:55], v[144:147]
    ds_read_b128 v[0:3], v26 offset:256
    v_mfma_f32_16x16x32_bf16 v[144:147], v[4:7], v[56:59], v[144:147]
    ds_read_b128 v[4:7], v27 offset:256
    s_waitcnt lgkmcnt(6)
    v_mfma_f32_16x16x32_bf16 v[148:151], v[220:223], v[28:31], 0
    ds_read_b128 v[220:223], v24 offset:8192
    v_mfma_f32_16x16x32_bf16 v[148:151], v[224:227], v[32:35], v[148:151]
    ds_read_b128 v[224:227], v25 offset:8192
    s_waitcnt lgkmcnt(6)
    v_mfma_f32_16x16x32_bf16 v[148:151], v[228:231], v[36:39], v[148:151]
    ds_read_b128 v[228:231], v26 offset:8192
    v_mfma_f32_16x16x32_bf16 v[148:151], v[232:235], v[40:43], v[148:151]
    ds_read_b128 v[232:235], v27 offset:8192
    s_waitcnt lgkmcnt(6)
    v_mfma_f32_16x16x32_bf16 v[148:151], v[236:239], v[44:47], v[148:151]
    ds_read_b128 v[236:239], v24 offset:8448
    v_mfma_f32_16x16x32_bf16 v[148:151], v[240:243], v[48:51], v[148:151]
    ds_read_b128 v[240:243], v25 offset:8448
    s_waitcnt lgkmcnt(6)
    v_mfma_f32_16x16x32_bf16 v[148:151], v[0:3], v[52:55], v[148:151]
    ds_read_b128 v[0:3], v26 offset:8448
    v_mfma_f32_16x16x32_bf16 v[148:151], v[4:7], v[56:59], v[148:151]
    ds_read_b128 v[4:7], v27 offset:8448
    s_waitcnt lgkmcnt(6)
    v_mfma_f32_16x16x32_bf16 v[152:155], v[220:223], v[28:31], 0
    v_add_u32 v24, 65536, v20
    v_add_u32 v25, 65536, v21
    v_add_u32 v26, 65536, v22
    v_add_u32 v27, 65536, v23
    s_barrier
    ds_read_b64_tr_b16 v[220:221], v24 offset:0
    ds_read_b64_tr_b16 v[222:223], v24 offset:2048
    v_mfma_f32_16x16x32_bf16 v[152:155], v[224:227], v[32:35], v[152:155]
    ds_read_b64_tr_b16 v[224:225], v25 offset:0
    ds_read_b64_tr_b16 v[226:227], v25 offset:2048
    s_waitcnt lgkmcnt(8)
    v_mfma_f32_16x16x32_bf16 v[152:155], v[228:231], v[36:39], v[152:155]
    ds_read_b64_tr_b16 v[228:229], v26 offset:0
    ds_read_b64_tr_b16 v[230:231], v26 offset:2048
    v_mfma_f32_16x16x32_bf16 v[152:155], v[232:235], v[40:43], v[152:155]
    ds_read_b64_tr_b16 v[232:233], v27 offset:0
    ds_read_b64_tr_b16 v[234:235], v27 offset:2048
    s_waitcnt lgkmcnt(10)
    v_mfma_f32_16x16x32_bf16 v[152:155], v[236:239], v[44:47], v[152:155]
    ds_read_b64_tr_b16 v[236:237], v24 offset:4096
    ds_read_b64_tr_b16 v[238:239], v24 offset:6144
    v_mfma_f32_16x16x32_bf16 v[152:155], v[240:243], v[48:51], v[152:155]
    ds_read_b64_tr_b16 v[240:241], v25 offset:4096
    ds_read_b64_tr_b16 v[242:243], v25 offset:6144
    s_waitcnt lgkmcnt(12)
    v_mfma_f32_16x16x32_bf16 v[152:155], v[0:3], v[52:55], v[152:155]
    ds_read_b64_tr_b16 v[0:1], v26 offset:4096
    ds_read_b64_tr_b16 v[2:3], v26 offset:6144
    v_mfma_f32_16x16x32_bf16 v[152:155], v[4:7], v[56:59], v[152:155]
    v_max3_f32 v253, v108, v109, v110
    v_max3_f32 v253, v111, v112, v253
    v_max3_f32 v253, v113, v114, v253
    s_nop 7
    v_mul_f32 v204, v204, v247
    v_mul_f32 v205, v205, v247
    v_mul_f32 v206, v206, v247
    v_mul_f32 v207, v207, v247
    v_mul_f32 v208, v208, v247
    v_mul_f32 v209, v209, v247
    v_mul_f32 v210, v210, v247
    v_mul_f32 v211, v211, v247
    v_mul_f32 v212, v212, v247
    v_mul_f32 v213, v213, v247
    v_mul_f32 v214, v214, v247
    v_mul_f32 v215, v215, v247
    v_mul_f32 v216, v216, v247
    v_mul_f32 v217, v217, v247
    v_mul_f32 v218, v218, v247
    v_mul_f32 v219, v219, v247
    v_mul_f32 v12, v12, v247
    v_mul_f32 v13, v13, v247
    v_mul_f32 v14, v14, v247
    v_mul_f32 v15, v15, v247
    s_nop 0
    s_waitcnt lgkmcnt(10)
    v_mfma_f32_16x16x32_bf16 v[204:207], v[220:223], v[76:79], v[204:207]
    v_max_f32 v253, v115, v253
    v_max3_f32 v253, v116, v117, v253
    v_max3_f32 v253, v118, v119, v253
    ds_read_b64_tr_b16 v[4:5], v27 offset:4096
    ds_read_b64_tr_b16 v[6:7], v27 offset:6144
    ds_read_b64_tr_b16 v[220:221], v24 offset:8192
    ds_read_b64_tr_b16 v[222:223], v24 offset:10240
    v_mfma_f32_16x16x32_bf16 v[208:211], v[224:227], v[76:79], v[208:211]
    v_max3_f32 v253, v120, v121, v253
    v_max3_f32 v253, v122, v123, v253
    v_max3_f32 v253, v140, v141, v253
    s_waitcnt lgkmcnt(10)
    v_mfma_f32_16x16x32_bf16 v[212:215], v[228:231], v[76:79], v[212:215]
    v_max3_f32 v253, v142, v143, v253
    v_max3_f32 v253, v144, v145, v253
    v_max3_f32 v253, v146, v147, v253
    ds_read_b64_tr_b16 v[224:225], v25 offset:8192
    ds_read_b64_tr_b16 v[226:227], v25 offset:10240
    ds_read_b64_tr_b16 v[228:229], v26 offset:8192
    ds_read_b64_tr_b16 v[230:231], v26 offset:10240
    v_mfma_f32_16x16x32_bf16 v[216:219], v[232:235], v[76:79], v[216:219]
    v_mfma_f32_16x16x32_bf16 v[12:15], v[8:11], v[76:79], v[12:15]
    v_max3_f32 v253, v148, v149, v253
    v_max3_f32 v253, v150, v151, v253
    v_max3_f32 v253, v152, v153, v253
    s_waitcnt lgkmcnt(10)
    v_mfma_f32_16x16x32_bf16 v[204:207], v[236:239], v[80:83], v[204:207]
    v_max3_f32 v253, v154, v155, v253
    v_mul_f32 v253, s60, v253
    v_mov_b32 v254, v253
    ds_read_b64_tr_b16 v[232:233], v27 offset:8192
    ds_read_b64_tr_b16 v[234:235], v27 offset:10240
    ds_read_b64_tr_b16 v[236:237], v24 offset:12288
    ds_read_b64_tr_b16 v[238:239], v24 offset:14336
    v_mfma_f32_16x16x32_bf16 v[208:211], v[240:243], v[80:83], v[208:211]
    s_nop 1
    v_permlane16_swap_b32 v253, v254
    v_max_f32 v253, v253, v254
    s_waitcnt lgkmcnt(10)
    v_mfma_f32_16x16x32_bf16 v[212:215], v[0:3], v[80:83], v[212:215]
    v_mov_b32 v254, v253
    s_nop 1
    v_permlane32_swap_b32 v253, v254
    ds_read_b64_tr_b16 v[240:241], v25 offset:12288
    ds_read_b64_tr_b16 v[242:243], v25 offset:14336
    ds_read_b64_tr_b16 v[0:1], v26 offset:12288
    ds_read_b64_tr_b16 v[2:3], v26 offset:14336
    v_mfma_f32_16x16x32_bf16 v[216:219], v[4:7], v[80:83], v[216:219]
    v_mfma_f32_16x16x32_bf16 v[12:15], v[8:11], v[80:83], v[12:15]
    v_max_f32 v253, v253, v254
    v_max_f32 v253, v253, v244
    v_sub_f32 v248, v244, v253
    s_waitcnt lgkmcnt(10)
    v_mfma_f32_16x16x32_bf16 v[204:207], v[220:223], v[84:87], v[204:207]
    v_exp_f32 v248, v248
    v_mov_b32 v244, v253
    v_fma_f32 v108, v108, s60, -v244
    ds_read_b64_tr_b16 v[4:5], v27 offset:12288
    ds_read_b64_tr_b16 v[6:7], v27 offset:14336
    v_add_u32 v24, 81920, v16
    v_add_u32 v25, 81920, v17
    v_add_u32 v26, 81920, v18
    v_add_u32 v27, 81920, v19
    s_barrier
    ds_read_b128 v[220:223], v24 offset:0
    v_mfma_f32_16x16x32_bf16 v[208:211], v[224:227], v[84:87], v[208:211]
    v_fma_f32 v109, v109, s60, -v244
    v_fma_f32 v110, v110, s60, -v244
    v_fma_f32 v111, v111, s60, -v244
    ds_read_b128 v[224:227], v25 offset:0
    s_waitcnt lgkmcnt(10)
    v_mfma_f32_16x16x32_bf16 v[212:215], v[228:231], v[84:87], v[212:215]
    v_fma_f32 v112, v112, s60, -v244
    v_fma_f32 v113, v113, s60, -v244
    v_fma_f32 v114, v114, s60, -v244
    ds_read_b128 v[228:231], v26 offset:0
    v_mfma_f32_16x16x32_bf16 v[216:219], v[232:235], v[84:87], v[216:219]
    v_mfma_f32_16x16x32_bf16 v[12:15], v[8:11], v[84:87], v[12:15]
    v_fma_f32 v115, v115, s60, -v244
    v_exp_f32 v108, v108
    v_exp_f32 v109, v109
    ds_read_b128 v[232:235], v27 offset:0
    s_waitcnt lgkmcnt(8)
    v_mfma_f32_16x16x32_bf16 v[204:207], v[236:239], v[88:91], v[204:207]
    v_exp_f32 v110, v110
    v_exp_f32 v111, v111
    v_exp_f32 v112, v112
    ds_read_b128 v[236:239], v24 offset:256
    v_mfma_f32_16x16x32_bf16 v[208:211], v[240:243], v[88:91], v[208:211]
    v_exp_f32 v113, v113
    v_exp_f32 v114, v114
    v_exp_f32 v115, v115
    ds_read_b128 v[240:243], v25 offset:256
    s_waitcnt lgkmcnt(6)
    v_mfma_f32_16x16x32_bf16 v[212:215], v[0:3], v[88:91], v[212:215]
    v_cvt_pk_bf16_f32 v108, v108, v109
    v_cvt_pk_bf16_f32 v109, v110, v111
    v_cvt_pk_bf16_f32 v110, v112, v113
    ds_read_b128 v[0:3], v26 offset:256
    v_mfma_f32_16x16x32_bf16 v[216:219], v[4:7], v[88:91], v[216:219]
    v_mfma_f32_16x16x32_bf16 v[12:15], v[8:11], v[88:91], v[12:15]
    v_cvt_pk_bf16_f32 v111, v114, v115
    v_fma_f32 v116, v116, s60, -v244
    v_fma_f32 v117, v117, s60, -v244
    ds_read_b128 v[4:7], v27 offset:256
    s_waitcnt lgkmcnt(6)
    v_mfma_f32_16x16x32_bf16 v[124:127], v[220:223], v[28:31], 0
    v_fma_f32 v118, v118, s60, -v244
    v_fma_f32 v119, v119, s60, -v244
    v_fma_f32 v120, v120, s60, -v244
    ds_read_b128 v[220:223], v24 offset:8192
    v_mfma_f32_16x16x32_bf16 v[124:127], v[224:227], v[32:35], v[124:127]
    v_fma_f32 v121, v121, s60, -v244
    v_fma_f32 v122, v122, s60, -v244
    v_fma_f32 v123, v123, s60, -v244
    ds_read_b128 v[224:227], v25 offset:8192
    s_waitcnt lgkmcnt(6)
    v_mfma_f32_16x16x32_bf16 v[124:127], v[228:231], v[36:39], v[124:127]
    v_exp_f32 v116, v116
    v_exp_f32 v117, v117
    v_exp_f32 v118, v118
    ds_read_b128 v[228:231], v26 offset:8192
    v_mfma_f32_16x16x32_bf16 v[124:127], v[232:235], v[40:43], v[124:127]
    v_exp_f32 v119, v119
    v_exp_f32 v120, v120
    v_exp_f32 v121, v121
    ds_read_b128 v[232:235], v27 offset:8192
    s_waitcnt lgkmcnt(6)
    v_mfma_f32_16x16x32_bf16 v[124:127], v[236:239], v[44:47], v[124:127]
    v_exp_f32 v122, v122
    v_exp_f32 v123, v123
    v_cvt_pk_bf16_f32 v112, v116, v117
    ds_read_b128 v[236:239], v24 offset:8448
    v_mfma_f32_16x16x32_bf16 v[124:127], v[240:243], v[48:51], v[124:127]
    v_cvt_pk_bf16_f32 v113, v118, v119
    v_cvt_pk_bf16_f32 v114, v120, v121
    v_cvt_pk_bf16_f32 v115, v122, v123
    ds_read_b128 v[240:243], v25 offset:8448
    s_waitcnt lgkmcnt(6)
    v_mfma_f32_16x16x32_bf16 v[124:127], v[0:3], v[52:55], v[124:127]
    v_fma_f32 v140, v140, s60, -v244
    v_fma_f32 v141, v141, s60, -v244
    v_fma_f32 v142, v142, s60, -v244
    ds_read_b128 v[0:3], v26 offset:8448
    v_mfma_f32_16x16x32_bf16 v[124:127], v[4:7], v[56:59], v[124:127]
    v_fma_f32 v143, v143, s60, -v244
    v_fma_f32 v144, v144, s60, -v244
    v_fma_f32 v145, v145, s60, -v244
    ds_read_b128 v[4:7], v27 offset:8448
    s_waitcnt lgkmcnt(6)
    v_mfma_f32_16x16x32_bf16 v[128:131], v[220:223], v[28:31], 0
    v_fma_f32 v146, v146, s60, -v244
    v_fma_f32 v147, v147, s60, -v244
    v_exp_f32 v140, v140
    v_add_u32 v24, 98304, v16
    v_add_u32 v25, 98304, v17
    v_add_u32 v26, 98304, v18
    v_add_u32 v27, 98304, v19
    s_barrier
    ds_read_b128 v[220:223], v24 offset:0
    v_mfma_f32_16x16x32_bf16 v[128:131], v[224:227], v[32:35], v[128:131]
    v_exp_f32 v141, v141
    v_exp_f32 v142, v142
    v_exp_f32 v143, v143
    ds_read_b128 v[224:227], v25 offset:0
    s_waitcnt lgkmcnt(6)
    v_mfma_f32_16x16x32_bf16 v[128:131], v[228:231], v[36:39], v[128:131]
    v_exp_f32 v144, v144
    v_exp_f32 v145, v145
    v_exp_f32 v146, v146
    ds_read_b128 v[228:231], v26 offset:0
    v_mfma_f32_16x16x32_bf16 v[128:131], v[232:235], v[40:43], v[128:131]
    v_exp_f32 v147, v147
    v_cvt_pk_bf16_f32 v116, v140, v141
    v_cvt_pk_bf16_f32 v117, v142, v143
    ds_read_b128 v[232:235], v27 offset:0
    s_waitcnt lgkmcnt(6)
    v_mfma_f32_16x16x32_bf16 v[128:131], v[236:239], v[44:47], v[128:131]
    v_cvt_pk_bf16_f32 v118, v144, v145
    v_cvt_pk_bf16_f32 v119, v146, v147
    v_fma_f32 v148, v148, s60, -v244
    ds_read_b128 v[236:239], v24 offset:256
    v_mfma_f32_16x16x32_bf16 v[128:131], v[240:243], v[48:51], v[128:131]
    v_fma_f32 v149, v149, s60, -v244
    v_fma_f32 v150, v150, s60, -v244
    v_fma_f32 v151, v151, s60, -v244
    ds_read_b128 v[240:243], v25 offset:256
    s_waitcnt lgkmcnt(6)
    v_mfma_f32_16x16x32_bf16 v[128:131], v[0:3], v[52:55], v[128:131]
    v_fma_f32 v152, v152, s60, -v244
    v_fma_f32 v153, v153, s60, -v244
    v_fma_f32 v154, v154, s60, -v244
    ds_read_b128 v[0:3], v26 offset:256
    v_mfma_f32_16x16x32_bf16 v[128:131], v[4:7], v[56:59], v[128:131]
    v_fma_f32 v155, v155, s60, -v244
    v_exp_f32 v148, v148
    v_exp_f32 v149, v149
    ds_read_b128 v[4:7], v27 offset:256
    s_waitcnt lgkmcnt(6)
    v_mfma_f32_16x16x32_bf16 v[132:135], v[220:223], v[28:31], 0
    v_exp_f32 v150, v150
    v_exp_f32 v151, v151
    v_exp_f32 v152, v152
    ds_read_b128 v[220:223], v24 offset:8192
    v_mfma_f32_16x16x32_bf16 v[132:135], v[224:227], v[32:35], v[132:135]
    v_exp_f32 v153, v153
    v_exp_f32 v154, v154
    v_exp_f32 v155, v155
    ds_read_b128 v[224:227], v25 offset:8192
    s_waitcnt lgkmcnt(6)
    v_mfma_f32_16x16x32_bf16 v[132:135], v[228:231], v[36:39], v[132:135]
    v_cvt_pk_bf16_f32 v120, v148, v149
    v_cvt_pk_bf16_f32 v121, v150, v151
    v_cvt_pk_bf16_f32 v122, v152, v153
    ds_read_b128 v[228:231], v26 offset:8192
    v_mfma_f32_16x16x32_bf16 v[132:135], v[232:235], v[40:43], v[132:135]
    v_cvt_pk_bf16_f32 v123, v154, v155
    ds_read_b128 v[232:235], v27 offset:8192
    s_waitcnt lgkmcnt(6)
    v_mfma_f32_16x16x32_bf16 v[132:135], v[236:239], v[44:47], v[132:135]
    ds_read_b128 v[236:239], v24 offset:8448
    v_mfma_f32_16x16x32_bf16 v[132:135], v[240:243], v[48:51], v[132:135]
    ds_read_b128 v[240:243], v25 offset:8448
    s_waitcnt lgkmcnt(6)
    v_mfma_f32_16x16x32_bf16 v[132:135], v[0:3], v[52:55], v[132:135]
    ds_read_b128 v[0:3], v26 offset:8448
    v_mfma_f32_16x16x32_bf16 v[132:135], v[4:7], v[56:59], v[132:135]
    ds_read_b128 v[4:7], v27 offset:8448
    s_waitcnt lgkmcnt(6)
    v_mfma_f32_16x16x32_bf16 v[136:139], v[220:223], v[28:31], 0
    v_mov_b32 v24, v16
    v_mov_b32 v25, v17
    v_mov_b32 v26, v18
    v_mov_b32 v27, v19
    s_barrier
    ds_read_b128 v[220:223], v24 offset:0
    v_mfma_f32_16x16x32_bf16 v[136:139], v[224:227], v[32:35], v[136:139]
    ds_read_b128 v[224:227], v25 offset:0
    s_waitcnt lgkmcnt(6)
    v_mfma_f32_16x16x32_bf16 v[136:139], v[228:231], v[36:39], v[136:139]
    ds_read_b128 v[228:231], v26 offset:0
    v_mfma_f32_16x16x32_bf16 v[136:139], v[232:235], v[40:43], v[136:139]
    ds_read_b128 v[232:235], v27 offset:0
    s_waitcnt lgkmcnt(6)
    v_mfma_f32_16x16x32_bf16 v[136:139], v[236:239], v[44:47], v[136:139]
    ds_read_b128 v[236:239], v24 offset:256
    v_mfma_f32_16x16x32_bf16 v[136:139], v[240:243], v[48:51], v[136:139]
    ds_read_b128 v[240:243], v25 offset:256
    s_waitcnt lgkmcnt(6)
    v_mfma_f32_16x16x32_bf16 v[136:139], v[0:3], v[52:55], v[136:139]
    ds_read_b128 v[0:3], v26 offset:256
    v_mfma_f32_16x16x32_bf16 v[136:139], v[4:7], v[56:59], v[136:139]
    ds_read_b128 v[4:7], v27 offset:256
    s_waitcnt lgkmcnt(6)
    v_mfma_f32_16x16x32_bf16 v[156:159], v[220:223], v[28:31], 0
    ds_read_b128 v[220:223], v24 offset:8192
    v_mfma_f32_16x16x32_bf16 v[156:159], v[224:227], v[32:35], v[156:159]
    ds_read_b128 v[224:227], v25 offset:8192
    s_waitcnt lgkmcnt(6)
    v_mfma_f32_16x16x32_bf16 v[156:159], v[228:231], v[36:39], v[156:159]
    ds_read_b128 v[228:231], v26 offset:8192
    v_mfma_f32_16x16x32_bf16 v[156:159], v[232:235], v[40:43], v[156:159]
    ds_read_b128 v[232:235], v27 offset:8192
    s_waitcnt lgkmcnt(6)
    v_mfma_f32_16x16x32_bf16 v[156:159], v[236:239], v[44:47], v[156:159]
    ds_read_b128 v[236:239], v24 offset:8448
    v_mfma_f32_16x16x32_bf16 v[156:159], v[240:243], v[48:51], v[156:159]
    ds_read_b128 v[240:243], v25 offset:8448
    s_waitcnt lgkmcnt(6)
    v_mfma_f32_16x16x32_bf16 v[156:159], v[0:3], v[52:55], v[156:159]
    ds_read_b128 v[0:3], v26 offset:8448
    v_mfma_f32_16x16x32_bf16 v[156:159], v[4:7], v[56:59], v[156:159]
    ds_read_b128 v[4:7], v27 offset:8448
    s_waitcnt lgkmcnt(6)
    v_mfma_f32_16x16x32_bf16 v[160:163], v[220:223], v[28:31], 0
    v_add_u32 v24, 16384, v16
    v_add_u32 v25, 16384, v17
    v_add_u32 v26, 16384, v18
    v_add_u32 v27, 16384, v19
    s_barrier
    ds_read_b128 v[220:223], v24 offset:0
    v_mfma_f32_16x16x32_bf16 v[160:163], v[224:227], v[32:35], v[160:163]
    ds_read_b128 v[224:227], v25 offset:0
    s_waitcnt lgkmcnt(6)
    v_mfma_f32_16x16x32_bf16 v[160:163], v[228:231], v[36:39], v[160:163]
    ds_read_b128 v[228:231], v26 offset:0
    v_mfma_f32_16x16x32_bf16 v[160:163], v[232:235], v[40:43], v[160:163]
    ds_read_b128 v[232:235], v27 offset:0
    s_waitcnt lgkmcnt(6)
    v_mfma_f32_16x16x32_bf16 v[160:163], v[236:239], v[44:47], v[160:163]
    ds_read_b128 v[236:239], v24 offset:256
    v_mfma_f32_16x16x32_bf16 v[160:163], v[240:243], v[48:51], v[160:163]
    ds_read_b128 v[240:243], v25 offset:256
    s_waitcnt lgkmcnt(6)
    v_mfma_f32_16x16x32_bf16 v[160:163], v[0:3], v[52:55], v[160:163]
    ds_read_b128 v[0:3], v26 offset:256
    v_mfma_f32_16x16x32_bf16 v[160:163], v[4:7], v[56:59], v[160:163]
    ds_read_b128 v[4:7], v27 offset:256
    s_waitcnt lgkmcnt(6)
    v_mfma_f32_16x16x32_bf16 v[164:167], v[220:223], v[28:31], 0
    ds_read_b128 v[220:223], v24 offset:8192
    v_mfma_f32_16x16x32_bf16 v[164:167], v[224:227], v[32:35], v[164:167]
    ds_read_b128 v[224:227], v25 offset:8192
    s_waitcnt lgkmcnt(6)
    v_mfma_f32_16x16x32_bf16 v[164:167], v[228:231], v[36:39], v[164:167]
    ds_read_b128 v[228:231], v26 offset:8192
    v_mfma_f32_16x16x32_bf16 v[164:167], v[232:235], v[40:43], v[164:167]
    ds_read_b128 v[232:235], v27 offset:8192
    s_waitcnt lgkmcnt(6)
    v_mfma_f32_16x16x32_bf16 v[164:167], v[236:239], v[44:47], v[164:167]
    ds_read_b128 v[236:239], v24 offset:8448
    v_mfma_f32_16x16x32_bf16 v[164:167], v[240:243], v[48:51], v[164:167]
    ds_read_b128 v[240:243], v25 offset:8448
    s_waitcnt lgkmcnt(6)
    v_mfma_f32_16x16x32_bf16 v[164:167], v[0:3], v[52:55], v[164:167]
    ds_read_b128 v[0:3], v26 offset:8448
    v_mfma_f32_16x16x32_bf16 v[164:167], v[4:7], v[56:59], v[164:167]
    ds_read_b128 v[4:7], v27 offset:8448
    s_waitcnt lgkmcnt(6)
    v_mfma_f32_16x16x32_bf16 v[168:171], v[220:223], v[28:31], 0
    v_add_u32 v24, 32768, v20
    v_add_u32 v25, 32768, v21
    v_add_u32 v26, 32768, v22
    v_add_u32 v27, 32768, v23
    s_barrier
    ds_read_b64_tr_b16 v[220:221], v24 offset:0
    ds_read_b64_tr_b16 v[222:223], v24 offset:2048
    v_mfma_f32_16x16x32_bf16 v[168:171], v[224:227], v[32:35], v[168:171]
    ds_read_b64_tr_b16 v[224:225], v25 offset:0
    ds_read_b64_tr_b16 v[226:227], v25 offset:2048
    s_waitcnt lgkmcnt(8)
    v_mfma_f32_16x16x32_bf16 v[168:171], v[228:231], v[36:39], v[168:171]
    ds_read_b64_tr_b16 v[228:229], v26 offset:0
    ds_read_b64_tr_b16 v[230:231], v26 offset:2048
    v_mfma_f32_16x16x32_bf16 v[168:171], v[232:235], v[40:43], v[168:171]
    ds_read_b64_tr_b16 v[232:233], v27 offset:0
    ds_read_b64_tr_b16 v[234:235], v27 offset:2048
    s_waitcnt lgkmcnt(10)
    v_mfma_f32_16x16x32_bf16 v[168:171], v[236:239], v[44:47], v[168:171]
    ds_read_b64_tr_b16 v[236:237], v24 offset:4096
    ds_read_b64_tr_b16 v[238:239], v24 offset:6144
    v_mfma_f32_16x16x32_bf16 v[168:171], v[240:243], v[48:51], v[168:171]
    ds_read_b64_tr_b16 v[240:241], v25 offset:4096
    ds_read_b64_tr_b16 v[242:243], v25 offset:6144
    s_waitcnt lgkmcnt(12)
    v_mfma_f32_16x16x32_bf16 v[168:171], v[0:3], v[52:55], v[168:171]
    ds_read_b64_tr_b16 v[0:1], v26 offset:4096
    ds_read_b64_tr_b16 v[2:3], v26 offset:6144
    v_mfma_f32_16x16x32_bf16 v[168:171], v[4:7], v[56:59], v[168:171]
    v_max3_f32 v253, v124, v125, v126
    v_max3_f32 v253, v127, v128, v253
    v_max3_f32 v253, v129, v130, v253
    s_nop 7
    v_mul_f32 v204, v204, v248
    v_mul_f32 v205, v205, v248
    v_mul_f32 v206, v206, v248
    v_mul_f32 v207, v207, v248
    v_mul_f32 v208, v208, v248
    v_mul_f32 v209, v209, v248
    v_mul_f32 v210, v210, v248
    v_mul_f32 v211, v211, v248
    v_mul_f32 v212, v212, v248
    v_mul_f32 v213, v213, v248
    v_mul_f32 v214, v214, v248
    v_mul_f32 v215, v215, v248
    v_mul_f32 v216, v216, v248
    v_mul_f32 v217, v217, v248
    v_mul_f32 v218, v218, v248
    v_mul_f32 v219, v219, v248
    v_mul_f32 v12, v12, v248
    v_mul_f32 v13, v13, v248
    v_mul_f32 v14, v14, v248
    v_mul_f32 v15, v15, v248
    s_nop 0
    s_waitcnt lgkmcnt(10)
    v_mfma_f32_16x16x32_bf16 v[204:207], v[220:223], v[108:111], v[204:207]
    v_max_f32 v253, v131, v253
    v_max3_f32 v253, v132, v133, v253
    v_max3_f32 v253, v134, v135, v253
    ds_read_b64_tr_b16 v[4:5], v27 offset:4096
    ds_read_b64_tr_b16 v[6:7], v27 offset:6144
    ds_read_b64_tr_b16 v[220:221], v24 offset:8192
    ds_read_b64_tr_b16 v[222:223], v24 offset:10240
    v_mfma_f32_16x16x32_bf16 v[208:211], v[224:227], v[108:111], v[208:211]
    v_max3_f32 v253, v136, v137, v253
    v_max3_f32 v253, v138, v139, v253
    v_max3_f32 v253, v156, v157, v253
    s_waitcnt lgkmcnt(10)
    v_mfma_f32_16x16x32_bf16 v[212:215], v[228:231], v[108:111], v[212:215]
    v_max3_f32 v253, v158, v159, v253
    v_max3_f32 v253, v160, v161, v253
    v_max3_f32 v253, v162, v163, v253
    ds_read_b64_tr_b16 v[224:225], v25 offset:8192
    ds_read_b64_tr_b16 v[226:227], v25 offset:10240
    ds_read_b64_tr_b16 v[228:229], v26 offset:8192
    ds_read_b64_tr_b16 v[230:231], v26 offset:10240
    v_mfma_f32_16x16x32_bf16 v[216:219], v[232:235], v[108:111], v[216:219]
    v_mfma_f32_16x16x32_bf16 v[12:15], v[8:11], v[108:111], v[12:15]
    v_max3_f32 v253, v164, v165, v253
    v_max3_f32 v253, v166, v167, v253
    v_max3_f32 v253, v168, v169, v253
    s_waitcnt lgkmcnt(10)
    v_mfma_f32_16x16x32_bf16 v[204:207], v[236:239], v[112:115], v[204:207]
    v_max3_f32 v253, v170, v171, v253
    v_mul_f32 v253, s60, v253
    v_mov_b32 v254, v253
    ds_read_b64_tr_b16 v[232:233], v27 offset:8192
    ds_read_b64_tr_b16 v[234:235], v27 offset:10240
    ds_read_b64_tr_b16 v[236:237], v24 offset:12288
    ds_read_b64_tr_b16 v[238:239], v24 offset:14336
    v_mfma_f32_16x16x32_bf16 v[208:211], v[240:243], v[112:115], v[208:211]
    s_nop 1
    v_permlane16_swap_b32 v253, v254
    v_max_f32 v253, v253, v254
    s_waitcnt lgkmcnt(10)
    v_mfma_f32_16x16x32_bf16 v[212:215], v[0:3], v[112:115], v[212:215]
    v_mov_b32 v254, v253
    s_nop 1
    v_permlane32_swap_b32 v253, v254
    ds_read_b64_tr_b16 v[240:241], v25 offset:12288
    ds_read_b64_tr_b16 v[242:243], v25 offset:14336
    ds_read_b64_tr_b16 v[0:1], v26 offset:12288
    ds_read_b64_tr_b16 v[2:3], v26 offset:14336
    v_mfma_f32_16x16x32_bf16 v[216:219], v[4:7], v[112:115], v[216:219]
    v_mfma_f32_16x16x32_bf16 v[12:15], v[8:11], v[112:115], v[12:15]
    v_max_f32 v253, v253, v254
    v_max_f32 v253, v253, v244
    v_sub_f32 v249, v244, v253
    s_waitcnt lgkmcnt(10)
    v_mfma_f32_16x16x32_bf16 v[204:207], v[220:223], v[116:119], v[204:207]
    v_exp_f32 v249, v249
    v_mov_b32 v244, v253
    v_fma_f32 v124, v124, s60, -v244
    ds_read_b64_tr_b16 v[4:5], v27 offset:12288
    ds_read_b64_tr_b16 v[6:7], v27 offset:14336
    v_add_u32 v24, 49152, v16
    v_add_u32 v25, 49152, v17
    v_add_u32 v26, 49152, v18
    v_add_u32 v27, 49152, v19
    s_barrier
    ds_read_b128 v[220:223], v24 offset:0
    v_mfma_f32_16x16x32_bf16 v[208:211], v[224:227], v[116:119], v[208:211]
    v_fma_f32 v125, v125, s60, -v244
    v_fma_f32 v126, v126, s60, -v244
    v_fma_f32 v127, v127, s60, -v244
    ds_read_b128 v[224:227], v25 offset:0
    s_waitcnt lgkmcnt(10)
    v_mfma_f32_16x16x32_bf16 v[212:215], v[228:231], v[116:119], v[212:215]
    v_fma_f32 v128, v128, s60, -v244
    v_fma_f32 v129, v129, s60, -v244
    v_fma_f32 v130, v130, s60, -v244
    ds_read_b128 v[228:231], v26 offset:0
    v_mfma_f32_16x16x32_bf16 v[216:219], v[232:235], v[116:119], v[216:219]
    v_mfma_f32_16x16x32_bf16 v[12:15], v[8:11], v[116:119], v[12:15]
    v_fma_f32 v131, v131, s60, -v244
    v_exp_f32 v124, v124
    v_exp_f32 v125, v125
    ds_read_b128 v[232:235], v27 offset:0
    s_waitcnt lgkmcnt(8)
    v_mfma_f32_16x16x32_bf16 v[204:207], v[236:239], v[120:123], v[204:207]
    v_exp_f32 v126, v126
    v_exp_f32 v127, v127
    v_exp_f32 v128, v128
    ds_read_b128 v[236:239], v24 offset:256
    v_mfma_f32_16x16x32_bf16 v[208:211], v[240:243], v[120:123], v[208:211]
    v_exp_f32 v129, v129
    v_exp_f32 v130, v130
    v_exp_f32 v131, v131
    ds_read_b128 v[240:243], v25 offset:256
    s_waitcnt lgkmcnt(6)
    v_mfma_f32_16x16x32_bf16 v[212:215], v[0:3], v[120:123], v[212:215]
    v_cvt_pk_bf16_f32 v124, v124, v125
    v_cvt_pk_bf16_f32 v125, v126, v127
    v_cvt_pk_bf16_f32 v126, v128, v129
    ds_read_b128 v[0:3], v26 offset:256
    v_mfma_f32_16x16x32_bf16 v[216:219], v[4:7], v[120:123], v[216:219]
    v_mfma_f32_16x16x32_bf16 v[12:15], v[8:11], v[120:123], v[12:15]
    v_cvt_pk_bf16_f32 v127, v130, v131
    v_fma_f32 v132, v132, s60, -v244
    v_fma_f32 v133, v133, s60, -v244
    ds_read_b128 v[4:7], v27 offset:256
    s_waitcnt lgkmcnt(6)
    v_mfma_f32_16x16x32_bf16 v[140:143], v[220:223], v[28:31], 0
    v_fma_f32 v134, v134, s60, -v244
    v_fma_f32 v135, v135, s60, -v244
    v_fma_f32 v136, v136, s60, -v244
    ds_read_b128 v[220:223], v24 offset:8192
    v_mfma_f32_16x16x32_bf16 v[140:143], v[224:227], v[32:35], v[140:143]
    v_fma_f32 v137, v137, s60, -v244
    v_fma_f32 v138, v138, s60, -v244
    v_fma_f32 v139, v139, s60, -v244
    ds_read_b128 v[224:227], v25 offset:8192
    s_waitcnt lgkmcnt(6)
    v_mfma_f32_16x16x32_bf16 v[140:143], v[228:231], v[36:39], v[140:143]
    v_exp_f32 v132, v132
    v_exp_f32 v133, v133
    v_exp_f32 v134, v134
    ds_read_b128 v[228:231], v26 offset:8192
    v_mfma_f32_16x16x32_bf16 v[140:143], v[232:235], v[40:43], v[140:143]
    v_exp_f32 v135, v135
    v_exp_f32 v136, v136
    v_exp_f32 v137, v137
    ds_read_b128 v[232:235], v27 offset:8192
    s_waitcnt lgkmcnt(6)
    v_mfma_f32_16x16x32_bf16 v[140:143], v[236:239], v[44:47], v[140:143]
    v_exp_f32 v138, v138
    v_exp_f32 v139, v139
    v_cvt_pk_bf16_f32 v128, v132, v133
    ds_read_b128 v[236:239], v24 offset:8448
    v_mfma_f32_16x16x32_bf16 v[140:143], v[240:243], v[48:51], v[140:143]
    v_cvt_pk_bf16_f32 v129, v134, v135
    v_cvt_pk_bf16_f32 v130, v136, v137
    v_cvt_pk_bf16_f32 v131, v138, v139
    ds_read_b128 v[240:243], v25 offset:8448
    s_waitcnt lgkmcnt(6)
    v_mfma_f32_16x16x32_bf16 v[140:143], v[0:3], v[52:55], v[140:143]
    v_fma_f32 v156, v156, s60, -v244
    v_fma_f32 v157, v157, s60, -v244
    v_fma_f32 v158, v158, s60, -v244
    ds_read_b128 v[0:3], v26 offset:8448
    v_mfma_f32_16x16x32_bf16 v[140:143], v[4:7], v[56:59], v[140:143]
    v_fma_f32 v159, v159, s60, -v244
    v_fma_f32 v160, v160, s60, -v244
    v_fma_f32 v161, v161, s60, -v244
    ds_read_b128 v[4:7], v27 offset:8448
    s_waitcnt lgkmcnt(6)
    v_mfma_f32_16x16x32_bf16 v[144:147], v[220:223], v[28:31], 0
    v_fma_f32 v162, v162, s60, -v244
    v_fma_f32 v163, v163, s60, -v244
    v_exp_f32 v156, v156
    v_add_u32 v24, 65536, v16
    v_add_u32 v25, 65536, v17
    v_add_u32 v26, 65536, v18
    v_add_u32 v27, 65536, v19
    s_barrier
    ds_read_b128 v[220:223], v24 offset:0
    v_mfma_f32_16x16x32_bf16 v[144:147], v[224:227], v[32:35], v[144:147]
    v_exp_f32 v157, v157
    v_exp_f32 v158, v158
    v_exp_f32 v159, v159
    ds_read_b128 v[224:227], v25 offset:0
    s_waitcnt lgkmcnt(6)
    v_mfma_f32_16x16x32_bf16 v[144:147], v[228:231], v[36:39], v[144:147]
    v_exp_f32 v160, v160
    v_exp_f32 v161, v161
    v_exp_f32 v162, v162
    ds_read_b128 v[228:231], v26 offset:0
    v_mfma_f32_16x16x32_bf16 v[144:147], v[232:235], v[40:43], v[144:147]
    v_exp_f32 v163, v163
    v_cvt_pk_bf16_f32 v132, v156, v157
    v_cvt_pk_bf16_f32 v133, v158, v159
    ds_read_b128 v[232:235], v27 offset:0
    s_waitcnt lgkmcnt(6)
    v_mfma_f32_16x16x32_bf16 v[144:147], v[236:239], v[44:47], v[144:147]
    v_cvt_pk_bf16_f32 v134, v160, v161
    v_cvt_pk_bf16_f32 v135, v162, v163
    v_fma_f32 v164, v164, s60, -v244
    ds_read_b128 v[236:239], v24 offset:256
    v_mfma_f32_16x16x32_bf16 v[144:147], v[240:243], v[48:51], v[144:147]
    v_fma_f32 v165, v165, s60, -v244
    v_fma_f32 v166, v166, s60, -v244
    v_fma_f32 v167, v167, s60, -v244
    ds_read_b128 v[240:243], v25 offset:256
    s_waitcnt lgkmcnt(6)
    v_mfma_f32_16x16x32_bf16 v[144:147], v[0:3], v[52:55], v[144:147]
    v_fma_f32 v168, v168, s60, -v244
    v_fma_f32 v169, v169, s60, -v244
    v_fma_f32 v170, v170, s60, -v244
    ds_read_b128 v[0:3], v26 offset:256
    v_mfma_f32_16x16x32_bf16 v[144:147], v[4:7], v[56:59], v[144:147]
    v_fma_f32 v171, v171, s60, -v244
    v_exp_f32 v164, v164
    v_exp_f32 v165, v165
    ds_read_b128 v[4:7], v27 offset:256
    s_waitcnt lgkmcnt(6)
    v_mfma_f32_16x16x32_bf16 v[148:151], v[220:223], v[28:31], 0
    v_exp_f32 v166, v166
    v_exp_f32 v167, v167
    v_exp_f32 v168, v168
    ds_read_b128 v[220:223], v24 offset:8192
    v_mfma_f32_16x16x32_bf16 v[148:151], v[224:227], v[32:35], v[148:151]
    v_exp_f32 v169, v169
    v_exp_f32 v170, v170
    v_exp_f32 v171, v171
    ds_read_b128 v[224:227], v25 offset:8192
    s_waitcnt lgkmcnt(6)
    v_mfma_f32_16x16x32_bf16 v[148:151], v[228:231], v[36:39], v[148:151]
    v_cvt_pk_bf16_f32 v136, v164, v165
    v_cvt_pk_bf16_f32 v137, v166, v167
    v_cvt_pk_bf16_f32 v138, v168, v169
    ds_read_b128 v[228:231], v26 offset:8192
    v_mfma_f32_16x16x32_bf16 v[148:151], v[232:235], v[40:43], v[148:151]
    v_cvt_pk_bf16_f32 v139, v170, v171
    ds_read_b128 v[232:235], v27 offset:8192
    s_waitcnt lgkmcnt(6)
    v_mfma_f32_16x16x32_bf16 v[148:151], v[236:239], v[44:47], v[148:151]
    ds_read_b128 v[236:239], v24 offset:8448
    v_mfma_f32_16x16x32_bf16 v[148:151], v[240:243], v[48:51], v[148:151]
    ds_read_b128 v[240:243], v25 offset:8448
    s_waitcnt lgkmcnt(6)
    v_mfma_f32_16x16x32_bf16 v[148:151], v[0:3], v[52:55], v[148:151]
    ds_read_b128 v[0:3], v26 offset:8448
    v_mfma_f32_16x16x32_bf16 v[148:151], v[4:7], v[56:59], v[148:151]
    ds_read_b128 v[4:7], v27 offset:8448
    s_waitcnt lgkmcnt(6)
    v_mfma_f32_16x16x32_bf16 v[152:155], v[220:223], v[28:31], 0
    v_add_u32 v24, 81920, v16
    v_add_u32 v25, 81920, v17
    v_add_u32 v26, 81920, v18
    v_add_u32 v27, 81920, v19
    s_barrier
    ds_read_b128 v[220:223], v24 offset:0
    v_mfma_f32_16x16x32_bf16 v[152:155], v[224:227], v[32:35], v[152:155]
    ds_read_b128 v[224:227], v25 offset:0
    s_waitcnt lgkmcnt(6)
    v_mfma_f32_16x16x32_bf16 v[152:155], v[228:231], v[36:39], v[152:155]
    ds_read_b128 v[228:231], v26 offset:0
    v_mfma_f32_16x16x32_bf16 v[152:155], v[232:235], v[40:43], v[152:155]
    ds_read_b128 v[232:235], v27 offset:0
    s_waitcnt lgkmcnt(6)
    v_mfma_f32_16x16x32_bf16 v[152:155], v[236:239], v[44:47], v[152:155]
    ds_read_b128 v[236:239], v24 offset:256
    v_mfma_f32_16x16x32_bf16 v[152:155], v[240:243], v[48:51], v[152:155]
    ds_read_b128 v[240:243], v25 offset:256
    s_waitcnt lgkmcnt(6)
    v_mfma_f32_16x16x32_bf16 v[152:155], v[0:3], v[52:55], v[152:155]
    ds_read_b128 v[0:3], v26 offset:256
    v_mfma_f32_16x16x32_bf16 v[152:155], v[4:7], v[56:59], v[152:155]
    ds_read_b128 v[4:7], v27 offset:256
    s_waitcnt lgkmcnt(6)
    v_mfma_f32_16x16x32_bf16 v[172:175], v[220:223], v[28:31], 0
    ds_read_b128 v[220:223], v24 offset:8192
    v_mfma_f32_16x16x32_bf16 v[172:175], v[224:227], v[32:35], v[172:175]
    ds_read_b128 v[224:227], v25 offset:8192
    s_waitcnt lgkmcnt(6)
    v_mfma_f32_16x16x32_bf16 v[172:175], v[228:231], v[36:39], v[172:175]
    ds_read_b128 v[228:231], v26 offset:8192
    v_mfma_f32_16x16x32_bf16 v[172:175], v[232:235], v[40:43], v[172:175]
    ds_read_b128 v[232:235], v27 offset:8192
    s_waitcnt lgkmcnt(6)
    v_mfma_f32_16x16x32_bf16 v[172:175], v[236:239], v[44:47], v[172:175]
    ds_read_b128 v[236:239], v24 offset:8448
    v_mfma_f32_16x16x32_bf16 v[172:175], v[240:243], v[48:51], v[172:175]
    ds_read_b128 v[240:243], v25 offset:8448
    s_waitcnt lgkmcnt(6)
    v_mfma_f32_16x16x32_bf16 v[172:175], v[0:3], v[52:55], v[172:175]
    ds_read_b128 v[0:3], v26 offset:8448
    v_mfma_f32_16x16x32_bf16 v[172:175], v[4:7], v[56:59], v[172:175]
    ds_read_b128 v[4:7], v27 offset:8448
    s_waitcnt lgkmcnt(6)
    v_mfma_f32_16x16x32_bf16 v[176:179], v[220:223], v[28:31], 0
    v_add_u32 v24, 98304, v16
    v_add_u32 v25, 98304, v17
    v_add_u32 v26, 98304, v18
    v_add_u32 v27, 98304, v19
    s_barrier
    ds_read_b128 v[220:223], v24 offset:0
    v_mfma_f32_16x16x32_bf16 v[176:179], v[224:227], v[32:35], v[176:179]
    ds_read_b128 v[224:227], v25 offset:0
    s_waitcnt lgkmcnt(6)
    v_mfma_f32_16x16x32_bf16 v[176:179], v[228:231], v[36:39], v[176:179]
    ds_read_b128 v[228:231], v26 offset:0
    v_mfma_f32_16x16x32_bf16 v[176:179], v[232:235], v[40:43], v[176:179]
    ds_read_b128 v[232:235], v27 offset:0
    s_waitcnt lgkmcnt(6)
    v_mfma_f32_16x16x32_bf16 v[176:179], v[236:239], v[44:47], v[176:179]
    ds_read_b128 v[236:239], v24 offset:256
    v_mfma_f32_16x16x32_bf16 v[176:179], v[240:243], v[48:51], v[176:179]
    ds_read_b128 v[240:243], v25 offset:256
    s_waitcnt lgkmcnt(6)
    v_mfma_f32_16x16x32_bf16 v[176:179], v[0:3], v[52:55], v[176:179]
    ds_read_b128 v[0:3], v26 offset:256
    v_mfma_f32_16x16x32_bf16 v[176:179], v[4:7], v[56:59], v[176:179]
    ds_read_b128 v[4:7], v27 offset:256
    s_waitcnt lgkmcnt(6)
    v_mfma_f32_16x16x32_bf16 v[180:183], v[220:223], v[28:31], 0
    ds_read_b128 v[220:223], v24 offset:8192
    v_mfma_f32_16x16x32_bf16 v[180:183], v[224:227], v[32:35], v[180:183]
    ds_read_b128 v[224:227], v25 offset:8192
    s_waitcnt lgkmcnt(6)
    v_mfma_f32_16x16x32_bf16 v[180:183], v[228:231], v[36:39], v[180:183]
    ds_read_b128 v[228:231], v26 offset:8192
    v_mfma_f32_16x16x32_bf16 v[180:183], v[232:235], v[40:43], v[180:183]
    ds_read_b128 v[232:235], v27 offset:8192
    s_waitcnt lgkmcnt(6)
    v_mfma_f32_16x16x32_bf16 v[180:183], v[236:239], v[44:47], v[180:183]
    ds_read_b128 v[236:239], v24 offset:8448
    v_mfma_f32_16x16x32_bf16 v[180:183], v[240:243], v[48:51], v[180:183]
    ds_read_b128 v[240:243], v25 offset:8448
    s_waitcnt lgkmcnt(6)
    v_mfma_f32_16x16x32_bf16 v[180:183], v[0:3], v[52:55], v[180:183]
    ds_read_b128 v[0:3], v26 offset:8448
    v_mfma_f32_16x16x32_bf16 v[180:183], v[4:7], v[56:59], v[180:183]
    ds_read_b128 v[4:7], v27 offset:8448
    s_waitcnt lgkmcnt(6)
    v_mfma_f32_16x16x32_bf16 v[184:187], v[220:223], v[28:31], 0
    v_mov_b32 v24, v20
    v_mov_b32 v25, v21
    v_mov_b32 v26, v22
    v_mov_b32 v27, v23
    s_barrier
    ds_read_b64_tr_b16 v[220:221], v24 offset:0
    ds_read_b64_tr_b16 v[222:223], v24 offset:2048
    v_mfma_f32_16x16x32_bf16 v[184:187], v[224:227], v[32:35], v[184:187]
    ds_read_b64_tr_b16 v[224:225], v25 offset:0
    ds_read_b64_tr_b16 v[226:227], v25 offset:2048
    s_waitcnt lgkmcnt(8)
    v_mfma_f32_16x16x32_bf16 v[184:187], v[228:231], v[36:39], v[184:187]
    ds_read_b64_tr_b16 v[228:229], v26 offset:0
    ds_read_b64_tr_b16 v[230:231], v26 offset:2048
    v_mfma_f32_16x16x32_bf16 v[184:187], v[232:235], v[40:43], v[184:187]
    ds_read_b64_tr_b16 v[232:233], v27 offset:0
    ds_read_b64_tr_b16 v[234:235], v27 offset:2048
    s_waitcnt lgkmcnt(10)
    v_mfma_f32_16x16x32_bf16 v[184:187], v[236:239], v[44:47], v[184:187]
    ds_read_b64_tr_b16 v[236:237], v24 offset:4096
    ds_read_b64_tr_b16 v[238:239], v24 offset:6144
    v_mfma_f32_16x16x32_bf16 v[184:187], v[240:243], v[48:51], v[184:187]
    ds_read_b64_tr_b16 v[240:241], v25 offset:4096
    ds_read_b64_tr_b16 v[242:243], v25 offset:6144
    s_waitcnt lgkmcnt(12)
    v_mfma_f32_16x16x32_bf16 v[184:187], v[0:3], v[52:55], v[184:187]
    ds_read_b64_tr_b16 v[0:1], v26 offset:4096
    ds_read_b64_tr_b16 v[2:3], v26 offset:6144
    v_mfma_f32_16x16x32_bf16 v[184:187], v[4:7], v[56:59], v[184:187]
    v_max3_f32 v253, v140, v141, v142
    v_max3_f32 v253, v143, v144, v253
    v_max3_f32 v253, v145, v146, v253
    s_nop 7
    v_mul_f32 v204, v204, v249
    v_mul_f32 v205, v205, v249
    v_mul_f32 v206, v206, v249
    v_mul_f32 v207, v207, v249
    v_mul_f32 v208, v208, v249
    v_mul_f32 v209, v209, v249
    v_mul_f32 v210, v210, v249
    v_mul_f32 v211, v211, v249
    v_mul_f32 v212, v212, v249
    v_mul_f32 v213, v213, v249
    v_mul_f32 v214, v214, v249
    v_mul_f32 v215, v215, v249
    v_mul_f32 v216, v216, v249
    v_mul_f32 v217, v217, v249
    v_mul_f32 v218, v218, v249
    v_mul_f32 v219, v219, v249
    v_mul_f32 v12, v12, v249
    v_mul_f32 v13, v13, v249
    v_mul_f32 v14, v14, v249
    v_mul_f32 v15, v15, v249
    s_nop 0
    s_waitcnt lgkmcnt(10)
    v_mfma_f32_16x16x32_bf16 v[204:207], v[220:223], v[124:127], v[204:207]
    v_max_f32 v253, v147, v253
    v_max3_f32 v253, v148, v149, v253
    v_max3_f32 v253, v150, v151, v253
    ds_read_b64_tr_b16 v[4:5], v27 offset:4096
    ds_read_b64_tr_b16 v[6:7], v27 offset:6144
    ds_read_b64_tr_b16 v[220:221], v24 offset:8192
    ds_read_b64_tr_b16 v[222:223], v24 offset:10240
    v_mfma_f32_16x16x32_bf16 v[208:211], v[224:227], v[124:127], v[208:211]
    v_max3_f32 v253, v152, v153, v253
    v_max3_f32 v253, v154, v155, v253
    v_max3_f32 v253, v172, v173, v253
    s_waitcnt lgkmcnt(10)
    v_mfma_f32_16x16x32_bf16 v[212:215], v[228:231], v[124:127], v[212:215]
    v_max3_f32 v253, v174, v175, v253
    v_max3_f32 v253, v176, v177, v253
    v_max3_f32 v253, v178, v179, v253
    ds_read_b64_tr_b16 v[224:225], v25 offset:8192
    ds_read_b64_tr_b16 v[226:227], v25 offset:10240
    ds_read_b64_tr_b16 v[228:229], v26 offset:8192
    ds_read_b64_tr_b16 v[230:231], v26 offset:10240
    v_mfma_f32_16x16x32_bf16 v[216:219], v[232:235], v[124:127], v[216:219]
    v_mfma_f32_16x16x32_bf16 v[12:15], v[8:11], v[124:127], v[12:15]
    v_max3_f32 v253, v180, v181, v253
    v_max3_f32 v253, v182, v183, v253
    v_max3_f32 v253, v184, v185, v253
    s_waitcnt lgkmcnt(10)
    v_mfma_f32_16x16x32_bf16 v[204:207], v[236:239], v[128:131], v[204:207]
    v_max3_f32 v253, v186, v187, v253
    v_mul_f32 v253, s60, v253
    v_mov_b32 v254, v253
    ds_read_b64_tr_b16 v[232:233], v27 offset:8192
    ds_read_b64_tr_b16 v[234:235], v27 offset:10240
    ds_read_b64_tr_b16 v[236:237], v24 offset:12288
    ds_read_b64_tr_b16 v[238:239], v24 offset:14336
    v_mfma_f32_16x16x32_bf16 v[208:211], v[240:243], v[128:131], v[208:211]
    s_nop 1
    v_permlane16_swap_b32 v253, v254
    v_max_f32 v253, v253, v254
    s_waitcnt lgkmcnt(10)
    v_mfma_f32_16x16x32_bf16 v[212:215], v[0:3], v[128:131], v[212:215]
    v_mov_b32 v254, v253
    s_nop 1
    v_permlane32_swap_b32 v253, v254
    ds_read_b64_tr_b16 v[240:241], v25 offset:12288
    ds_read_b64_tr_b16 v[242:243], v25 offset:14336
    ds_read_b64_tr_b16 v[0:1], v26 offset:12288
    ds_read_b64_tr_b16 v[2:3], v26 offset:14336
    v_mfma_f32_16x16x32_bf16 v[216:219], v[4:7], v[128:131], v[216:219]
    v_mfma_f32_16x16x32_bf16 v[12:15], v[8:11], v[128:131], v[12:15]
    v_max_f32 v253, v253, v254
    v_max_f32 v253, v253, v244
    v_sub_f32 v250, v244, v253
    s_waitcnt lgkmcnt(10)
    v_mfma_f32_16x16x32_bf16 v[204:207], v[220:223], v[132:135], v[204:207]
    v_exp_f32 v250, v250
    v_mov_b32 v244, v253
    v_fma_f32 v140, v140, s60, -v244
    ds_read_b64_tr_b16 v[4:5], v27 offset:12288
    ds_read_b64_tr_b16 v[6:7], v27 offset:14336
    v_add_u32 v24, 16384, v16
    v_add_u32 v25, 16384, v17
    v_add_u32 v26, 16384, v18
    v_add_u32 v27, 16384, v19
    s_barrier
    ds_read_b128 v[220:223], v24 offset:0
    v_mfma_f32_16x16x32_bf16 v[208:211], v[224:227], v[132:135], v[208:211]
    v_fma_f32 v141, v141, s60, -v244
    v_fma_f32 v142, v142, s60, -v244
    v_fma_f32 v143, v143, s60, -v244
    ds_read_b128 v[224:227], v25 offset:0
    s_waitcnt lgkmcnt(10)
    v_mfma_f32_16x16x32_bf16 v[212:215], v[228:231], v[132:135], v[212:215]
    v_fma_f32 v144, v144, s60, -v244
    v_fma_f32 v145, v145, s60, -v244
    v_fma_f32 v146, v146, s60, -v244
    ds_read_b128 v[228:231], v26 offset:0
    v_mfma_f32_16x16x32_bf16 v[216:219], v[232:235], v[132:135], v[216:219]
    v_mfma_f32_16x16x32_bf16 v[12:15], v[8:11], v[132:135], v[12:15]
    v_fma_f32 v147, v147, s60, -v244
    v_exp_f32 v140, v140
    v_exp_f32 v141, v141
    ds_read_b128 v[232:235], v27 offset:0
    s_waitcnt lgkmcnt(8)
    v_mfma_f32_16x16x32_bf16 v[204:207], v[236:239], v[136:139], v[204:207]
    v_exp_f32 v142, v142
    v_exp_f32 v143, v143
    v_exp_f32 v144, v144
    ds_read_b128 v[236:239], v24 offset:256
    v_mfma_f32_16x16x32_bf16 v[208:211], v[240:243], v[136:139], v[208:211]
    v_exp_f32 v145, v145
    v_exp_f32 v146, v146
    v_exp_f32 v147, v147
    ds_read_b128 v[240:243], v25 offset:256
    s_waitcnt lgkmcnt(6)
    v_mfma_f32_16x16x32_bf16 v[212:215], v[0:3], v[136:139], v[212:215]
    v_cvt_pk_bf16_f32 v140, v140, v141
    v_cvt_pk_bf16_f32 v141, v142, v143
    v_cvt_pk_bf16_f32 v142, v144, v145
    ds_read_b128 v[0:3], v26 offset:256
    v_mfma_f32_16x16x32_bf16 v[216:219], v[4:7], v[136:139], v[216:219]
    v_mfma_f32_16x16x32_bf16 v[12:15], v[8:11], v[136:139], v[12:15]
    v_cvt_pk_bf16_f32 v143, v146, v147
    v_fma_f32 v148, v148, s60, -v244
    v_fma_f32 v149, v149, s60, -v244
    ds_read_b128 v[4:7], v27 offset:256
    s_waitcnt lgkmcnt(6)
    v_mfma_f32_16x16x32_bf16 v[156:159], v[220:223], v[28:31], 0
    v_fma_f32 v150, v150, s60, -v244
    v_fma_f32 v151, v151, s60, -v244
    v_fma_f32 v152, v152, s60, -v244
    ds_read_b128 v[220:223], v24 offset:8192
    v_mfma_f32_16x16x32_bf16 v[156:159], v[224:227], v[32:35], v[156:159]
    v_fma_f32 v153, v153, s60, -v244
    v_fma_f32 v154, v154, s60, -v244
    v_fma_f32 v155, v155, s60, -v244
    ds_read_b128 v[224:227], v25 offset:8192
    s_waitcnt lgkmcnt(6)
    v_mfma_f32_16x16x32_bf16 v[156:159], v[228:231], v[36:39], v[156:159]
    v_exp_f32 v148, v148
    v_exp_f32 v149, v149
    v_exp_f32 v150, v150
    ds_read_b128 v[228:231], v26 offset:8192
    v_mfma_f32_16x16x32_bf16 v[156:159], v[232:235], v[40:43], v[156:159]
    v_exp_f32 v151, v151
    v_exp_f32 v152, v152
    v_exp_f32 v153, v153
    ds_read_b128 v[232:235], v27 offset:8192
    s_waitcnt lgkmcnt(6)
    v_mfma_f32_16x16x32_bf16 v[156:159], v[236:239], v[44:47], v[156:159]
    v_exp_f32 v154, v154
    v_exp_f32 v155, v155
    v_cvt_pk_bf16_f32 v144, v148, v149
    ds_read_b128 v[236:239], v24 offset:8448
    v_mfma_f32_16x16x32_bf16 v[156:159], v[240:243], v[48:51], v[156:159]
    v_cvt_pk_bf16_f32 v145, v150, v151
    v_cvt_pk_bf16_f32 v146, v152, v153
    v_cvt_pk_bf16_f32 v147, v154, v155
    ds_read_b128 v[240:243], v25 offset:8448
    s_waitcnt lgkmcnt(6)
    v_mfma_f32_16x16x32_bf16 v[156:159], v[0:3], v[52:55], v[156:159]
    v_fma_f32 v172, v172, s60, -v244
    v_fma_f32 v173, v173, s60, -v244
    v_fma_f32 v174, v174, s60, -v244
    ds_read_b128 v[0:3], v26 offset:8448
    v_mfma_f32_16x16x32_bf16 v[156:159], v[4:7], v[56:59], v[156:159]
    v_fma_f32 v175, v175, s60, -v244
    v_fma_f32 v176, v176, s60, -v244
    v_fma_f32 v177, v177, s60, -v244
    ds_read_b128 v[4:7], v27 offset:8448
    s_waitcnt lgkmcnt(6)
    v_mfma_f32_16x16x32_bf16 v[160:163], v[220:223], v[28:31], 0
    v_fma_f32 v178, v178, s60, -v244
    v_fma_f32 v179, v179, s60, -v244
    v_exp_f32 v172, v172
    v_add_u32 v24, 32768, v16
    v_add_u32 v25, 32768, v17
    v_add_u32 v26, 32768, v18
    v_add_u32 v27, 32768, v19
    s_barrier
    ds_read_b128 v[220:223], v24 offset:0
    v_mfma_f32_16x16x32_bf16 v[160:163], v[224:227], v[32:35], v[160:163]
    v_exp_f32 v173, v173
    v_exp_f32 v174, v174
    v_exp_f32 v175, v175
    ds_read_b128 v[224:227], v25 offset:0
    s_waitcnt lgkmcnt(6)
    v_mfma_f32_16x16x32_bf16 v[160:163], v[228:231], v[36:39], v[160:163]
    v_exp_f32 v176, v176
    v_exp_f32 v177, v177
    v_exp_f32 v178, v178
    ds_read_b128 v[228:231], v26 offset:0
    v_mfma_f32_16x16x32_bf16 v[160:163], v[232:235], v[40:43], v[160:163]
    v_exp_f32 v179, v179
    v_cvt_pk_bf16_f32 v148, v172, v173
    v_cvt_pk_bf16_f32 v149, v174, v175
    ds_read_b128 v[232:235], v27 offset:0
    s_waitcnt lgkmcnt(6)
    v_mfma_f32_16x16x32_bf16 v[160:163], v[236:239], v[44:47], v[160:163]
    v_cvt_pk_bf16_f32 v150, v176, v177
    v_cvt_pk_bf16_f32 v151, v178, v179
    v_fma_f32 v180, v180, s60, -v244
    ds_read_b128 v[236:239], v24 offset:256
    v_mfma_f32_16x16x32_bf16 v[160:163], v[240:243], v[48:51], v[160:163]
    v_fma_f32 v181, v181, s60, -v244
    v_fma_f32 v182, v182, s60, -v244
    v_fma_f32 v183, v183, s60, -v244
    ds_read_b128 v[240:243], v25 offset:256
    s_waitcnt lgkmcnt(6)
    v_mfma_f32_16x16x32_bf16 v[160:163], v[0:3], v[52:55], v[160:163]
    v_fma_f32 v184, v184, s60, -v244
    v_fma_f32 v185, v185, s60, -v244
    v_fma_f32 v186, v186, s60, -v244
    ds_read_b128 v[0:3], v26 offset:256
    v_mfma_f32_16x16x32_bf16 v[160:163], v[4:7], v[56:59], v[160:163]
    v_fma_f32 v187, v187, s60, -v244
    v_exp_f32 v180, v180
    v_exp_f32 v181, v181
    ds_read_b128 v[4:7], v27 offset:256
    s_waitcnt lgkmcnt(6)
    v_mfma_f32_16x16x32_bf16 v[164:167], v[220:223], v[28:31], 0
    v_exp_f32 v182, v182
    v_exp_f32 v183, v183
    v_exp_f32 v184, v184
    ds_read_b128 v[220:223], v24 offset:8192
    v_mfma_f32_16x16x32_bf16 v[164:167], v[224:227], v[32:35], v[164:167]
    v_exp_f32 v185, v185
    v_exp_f32 v186, v186
    v_exp_f32 v187, v187
    ds_read_b128 v[224:227], v25 offset:8192
    s_waitcnt lgkmcnt(6)
    v_mfma_f32_16x16x32_bf16 v[164:167], v[228:231], v[36:39], v[164:167]
    v_cvt_pk_bf16_f32 v152, v180, v181
    v_cvt_pk_bf16_f32 v153, v182, v183
    v_cvt_pk_bf16_f32 v154, v184, v185
    ds_read_b128 v[228:231], v26 offset:8192
    v_mfma_f32_16x16x32_bf16 v[164:167], v[232:235], v[40:43], v[164:167]
    v_cvt_pk_bf16_f32 v155, v186, v187
    ds_read_b128 v[232:235], v27 offset:8192
    s_waitcnt lgkmcnt(6)
    v_mfma_f32_16x16x32_bf16 v[164:167], v[236:239], v[44:47], v[164:167]
    ds_read_b128 v[236:239], v24 offset:8448
    v_mfma_f32_16x16x32_bf16 v[164:167], v[240:243], v[48:51], v[164:167]
    ds_read_b128 v[240:243], v25 offset:8448
    s_waitcnt lgkmcnt(6)
    v_mfma_f32_16x16x32_bf16 v[164:167], v[0:3], v[52:55], v[164:167]
    ds_read_b128 v[0:3], v26 offset:8448
    v_mfma_f32_16x16x32_bf16 v[164:167], v[4:7], v[56:59], v[164:167]
    ds_read_b128 v[4:7], v27 offset:8448
    s_waitcnt lgkmcnt(6)
    v_mfma_f32_16x16x32_bf16 v[168:171], v[220:223], v[28:31], 0
    v_add_u32 v24, 49152, v16
    v_add_u32 v25, 49152, v17
    v_add_u32 v26, 49152, v18
    v_add_u32 v27, 49152, v19
    s_barrier
    ds_read_b128 v[220:223], v24 offset:0
    v_mfma_f32_16x16x32_bf16 v[168:171], v[224:227], v[32:35], v[168:171]
    ds_read_b128 v[224:227], v25 offset:0
    s_waitcnt lgkmcnt(6)
    v_mfma_f32_16x16x32_bf16 v[168:171], v[228:231], v[36:39], v[168:171]
    ds_read_b128 v[228:231], v26 offset:0
    v_mfma_f32_16x16x32_bf16 v[168:171], v[232:235], v[40:43], v[168:171]
    ds_read_b128 v[232:235], v27 offset:0
    s_waitcnt lgkmcnt(6)
    v_mfma_f32_16x16x32_bf16 v[168:171], v[236:239], v[44:47], v[168:171]
    ds_read_b128 v[236:239], v24 offset:256
    v_mfma_f32_16x16x32_bf16 v[168:171], v[240:243], v[48:51], v[168:171]
    ds_read_b128 v[240:243], v25 offset:256
    s_waitcnt lgkmcnt(6)
    v_mfma_f32_16x16x32_bf16 v[168:171], v[0:3], v[52:55], v[168:171]
    ds_read_b128 v[0:3], v26 offset:256
    v_mfma_f32_16x16x32_bf16 v[168:171], v[4:7], v[56:59], v[168:171]
    ds_read_b128 v[4:7], v27 offset:256
    s_waitcnt lgkmcnt(6)
    v_mfma_f32_16x16x32_bf16 v[188:191], v[220:223], v[28:31], 0
    ds_read_b128 v[220:223], v24 offset:8192
    v_mfma_f32_16x16x32_bf16 v[188:191], v[224:227], v[32:35], v[188:191]
    ds_read_b128 v[224:227], v25 offset:8192
    s_waitcnt lgkmcnt(6)
    v_mfma_f32_16x16x32_bf16 v[188:191], v[228:231], v[36:39], v[188:191]
    ds_read_b128 v[228:231], v26 offset:8192
    v_mfma_f32_16x16x32_bf16 v[188:191], v[232:235], v[40:43], v[188:191]
    ds_read_b128 v[232:235], v27 offset:8192
    s_waitcnt lgkmcnt(6)
    v_mfma_f32_16x16x32_bf16 v[188:191], v[236:239], v[44:47], v[188:191]
    ds_read_b128 v[236:239], v24 offset:8448
    v_mfma_f32_16x16x32_bf16 v[188:191], v[240:243], v[48:51], v[188:191]
    ds_read_b128 v[240:243], v25 offset:8448
    s_waitcnt lgkmcnt(6)
    v_mfma_f32_16x16x32_bf16 v[188:191], v[0:3], v[52:55], v[188:191]
    ds_read_b128 v[0:3], v26 offset:8448
    v_mfma_f32_16x16x32_bf16 v[188:191], v[4:7], v[56:59], v[188:191]
    ds_read_b128 v[4:7], v27 offset:8448
    s_waitcnt lgkmcnt(6)
    v_mfma_f32_16x16x32_bf16 v[192:195], v[220:223], v[28:31], 0
    v_add_u32 v24, 65536, v16
    v_add_u32 v25, 65536, v17
    v_add_u32 v26, 65536, v18
    v_add_u32 v27, 65536, v19
    s_barrier
    ds_read_b128 v[220:223], v24 offset:0
    v_mfma_f32_16x16x32_bf16 v[192:195], v[224:227], v[32:35], v[192:195]
    ds_read_b128 v[224:227], v25 offset:0
    s_waitcnt lgkmcnt(6)
    v_mfma_f32_16x16x32_bf16 v[192:195], v[228:231], v[36:39], v[192:195]
    ds_read_b128 v[228:231], v26 offset:0
    v_mfma_f32_16x16x32_bf16 v[192:195], v[232:235], v[40:43], v[192:195]
    ds_read_b128 v[232:235], v27 offset:0
    s_waitcnt lgkmcnt(6)
    v_mfma_f32_16x16x32_bf16 v[192:195], v[236:239], v[44:47], v[192:195]
    ds_read_b128 v[236:239], v24 offset:256
    v_mfma_f32_16x16x32_bf16 v[192:195], v[240:243], v[48:51], v[192:195]
    ds_read_b128 v[240:243], v25 offset:256
    s_waitcnt lgkmcnt(6)
    v_mfma_f32_16x16x32_bf16 v[192:195], v[0:3], v[52:55], v[192:195]
    ds_read_b128 v[0:3], v26 offset:256
    v_mfma_f32_16x16x32_bf16 v[192:195], v[4:7], v[56:59], v[192:195]
    ds_read_b128 v[4:7], v27 offset:256
    s_waitcnt lgkmcnt(6)
    v_mfma_f32_16x16x32_bf16 v[196:199], v[220:223], v[28:31], 0
    ds_read_b128 v[220:223], v24 offset:8192
    v_mfma_f32_16x16x32_bf16 v[196:199], v[224:227], v[32:35], v[196:199]
    ds_read_b128 v[224:227], v25 offset:8192
    s_waitcnt lgkmcnt(6)
    v_mfma_f32_16x16x32_bf16 v[196:199], v[228:231], v[36:39], v[196:199]
    ds_read_b128 v[228:231], v26 offset:8192
    v_mfma_f32_16x16x32_bf16 v[196:199], v[232:235], v[40:43], v[196:199]
    ds_read_b128 v[232:235], v27 offset:8192
    s_waitcnt lgkmcnt(6)
    v_mfma_f32_16x16x32_bf16 v[196:199], v[236:239], v[44:47], v[196:199]
    ds_read_b128 v[236:239], v24 offset:8448
    v_mfma_f32_16x16x32_bf16 v[196:199], v[240:243], v[48:51], v[196:199]
    ds_read_b128 v[240:243], v25 offset:8448
    s_waitcnt lgkmcnt(6)
    v_mfma_f32_16x16x32_bf16 v[196:199], v[0:3], v[52:55], v[196:199]
    ds_read_b128 v[0:3], v26 offset:8448
    v_mfma_f32_16x16x32_bf16 v[196:199], v[4:7], v[56:59], v[196:199]
    ds_read_b128 v[4:7], v27 offset:8448
    s_waitcnt lgkmcnt(6)
    v_mfma_f32_16x16x32_bf16 v[200:203], v[220:223], v[28:31], 0
    v_add_u32 v24, 81920, v20
    v_add_u32 v25, 81920, v21
    v_add_u32 v26, 81920, v22
    v_add_u32 v27, 81920, v23
    s_barrier
    ds_read_b64_tr_b16 v[220:221], v24 offset:0
    ds_read_b64_tr_b16 v[222:223], v24 offset:2048
    v_mfma_f32_16x16x32_bf16 v[200:203], v[224:227], v[32:35], v[200:203]
    ds_read_b64_tr_b16 v[224:225], v25 offset:0
    ds_read_b64_tr_b16 v[226:227], v25 offset:2048
    s_waitcnt lgkmcnt(8)
    v_mfma_f32_16x16x32_bf16 v[200:203], v[228:231], v[36:39], v[200:203]
    ds_read_b64_tr_b16 v[228:229], v26 offset:0
    ds_read_b64_tr_b16 v[230:231], v26 offset:2048
    v_mfma_f32_16x16x32_bf16 v[200:203], v[232:235], v[40:43], v[200:203]
    ds_read_b64_tr_b16 v[232:233], v27 offset:0
    ds_read_b64_tr_b16 v[234:235], v27 offset:2048
    s_waitcnt lgkmcnt(10)
    v_mfma_f32_16x16x32_bf16 v[200:203], v[236:239], v[44:47], v[200:203]
    ds_read_b64_tr_b16 v[236:237], v24 offset:4096
    ds_read_b64_tr_b16 v[238:239], v24 offset:6144
    v_mfma_f32_16x16x32_bf16 v[200:203], v[240:243], v[48:51], v[200:203]
    ds_read_b64_tr_b16 v[240:241], v25 offset:4096
    ds_read_b64_tr_b16 v[242:243], v25 offset:6144
    s_waitcnt lgkmcnt(12)
    v_mfma_f32_16x16x32_bf16 v[200:203], v[0:3], v[52:55], v[200:203]
    ds_read_b64_tr_b16 v[0:1], v26 offset:4096
    ds_read_b64_tr_b16 v[2:3], v26 offset:6144
    v_mfma_f32_16x16x32_bf16 v[200:203], v[4:7], v[56:59], v[200:203]
    v_max3_f32 v253, v156, v157, v158
    v_max3_f32 v253, v159, v160, v253
    v_max3_f32 v253, v161, v162, v253
    s_nop 7
    v_mul_f32 v204, v204, v250
    v_mul_f32 v205, v205, v250
    v_mul_f32 v206, v206, v250
    v_mul_f32 v207, v207, v250
    v_mul_f32 v208, v208, v250
    v_mul_f32 v209, v209, v250
    v_mul_f32 v210, v210, v250
    v_mul_f32 v211, v211, v250
    v_mul_f32 v212, v212, v250
    v_mul_f32 v213, v213, v250
    v_mul_f32 v214, v214, v250
    v_mul_f32 v215, v215, v250
    v_mul_f32 v216, v216, v250
    v_mul_f32 v217, v217, v250
    v_mul_f32 v218, v218, v250
    v_mul_f32 v219, v219, v250
    v_mul_f32 v12, v12, v250
    v_mul_f32 v13, v13, v250
    v_mul_f32 v14, v14, v250
    v_mul_f32 v15, v15, v250
    s_nop 0
    s_waitcnt lgkmcnt(10)
    v_mfma_f32_16x16x32_bf16 v[204:207], v[220:223], v[140:143], v[204:207]
    v_max_f32 v253, v163, v253
    v_max3_f32 v253, v164, v165, v253
    v_max3_f32 v253, v166, v167, v253
    ds_read_b64_tr_b16 v[4:5], v27 offset:4096
    ds_read_b64_tr_b16 v[6:7], v27 offset:6144
    ds_read_b64_tr_b16 v[220:221], v24 offset:8192
    ds_read_b64_tr_b16 v[222:223], v24 offset:10240
    v_mfma_f32_16x16x32_bf16 v[208:211], v[224:227], v[140:143], v[208:211]
    v_max3_f32 v253, v168, v169, v253
    v_max3_f32 v253, v170, v171, v253
    v_max3_f32 v253, v188, v189, v253
    s_waitcnt lgkmcnt(10)
    v_mfma_f32_16x16x32_bf16 v[212:215], v[228:231], v[140:143], v[212:215]
    v_max3_f32 v253, v190, v191, v253
    v_max3_f32 v253, v192, v193, v253
    v_max3_f32 v253, v194, v195, v253
    ds_read_b64_tr_b16 v[224:225], v25 offset:8192
    ds_read_b64_tr_b16 v[226:227], v25 offset:10240
    ds_read_b64_tr_b16 v[228:229], v26 offset:8192
    ds_read_b64_tr_b16 v[230:231], v26 offset:10240
    v_mfma_f32_16x16x32_bf16 v[216:219], v[232:235], v[140:143], v[216:219]
    v_mfma_f32_16x16x32_bf16 v[12:15], v[8:11], v[140:143], v[12:15]
    v_max3_f32 v253, v196, v197, v253
    v_max3_f32 v253, v198, v199, v253
    v_max3_f32 v253, v200, v201, v253
    s_waitcnt lgkmcnt(10)
    v_mfma_f32_16x16x32_bf16 v[204:207], v[236:239], v[144:147], v[204:207]
    v_max3_f32 v253, v202, v203, v253
    v_mul_f32 v253, s60, v253
    v_mov_b32 v254, v253
    ds_read_b64_tr_b16 v[232:233], v27 offset:8192
    ds_read_b64_tr_b16 v[234:235], v27 offset:10240
    ds_read_b64_tr_b16 v[236:237], v24 offset:12288
    ds_read_b64_tr_b16 v[238:239], v24 offset:14336
    v_mfma_f32_16x16x32_bf16 v[208:211], v[240:243], v[144:147], v[208:211]
    s_nop 1
    v_permlane16_swap_b32 v253, v254
    v_max_f32 v253, v253, v254
    s_waitcnt lgkmcnt(10)
    v_mfma_f32_16x16x32_bf16 v[212:215], v[0:3], v[144:147], v[212:215]
    v_mov_b32 v254, v253
    s_nop 1
    v_permlane32_swap_b32 v253, v254
    ds_read_b64_tr_b16 v[240:241], v25 offset:12288
    ds_read_b64_tr_b16 v[242:243], v25 offset:14336
    ds_read_b64_tr_b16 v[0:1], v26 offset:12288
    ds_read_b64_tr_b16 v[2:3], v26 offset:14336
    v_mfma_f32_16x16x32_bf16 v[216:219], v[4:7], v[144:147], v[216:219]
    v_mfma_f32_16x16x32_bf16 v[12:15], v[8:11], v[144:147], v[12:15]
    v_max_f32 v253, v253, v254
    v_max_f32 v253, v253, v244
    v_sub_f32 v251, v244, v253
    s_waitcnt lgkmcnt(10)
    v_mfma_f32_16x16x32_bf16 v[204:207], v[220:223], v[148:151], v[204:207]
    v_exp_f32 v251, v251
    v_mov_b32 v244, v253
    v_fma_f32 v156, v156, s60, -v244
    ds_read_b64_tr_b16 v[4:5], v27 offset:12288
    ds_read_b64_tr_b16 v[6:7], v27 offset:14336
    v_add_u32 v24, 98304, v16
    v_add_u32 v25, 98304, v17
    v_add_u32 v26, 98304, v18
    v_add_u32 v27, 98304, v19
    s_barrier
    ds_read_b128 v[220:223], v24 offset:0
    v_mfma_f32_16x16x32_bf16 v[208:211], v[224:227], v[148:151], v[208:211]
    v_fma_f32 v157, v157, s60, -v244
    v_fma_f32 v158, v158, s60, -v244
    v_fma_f32 v159, v159, s60, -v244
    ds_read_b128 v[224:227], v25 offset:0
    s_waitcnt lgkmcnt(10)
    v_mfma_f32_16x16x32_bf16 v[212:215], v[228:231], v[148:151], v[212:215]
    v_fma_f32 v160, v160, s60, -v244
    v_fma_f32 v161, v161, s60, -v244
    v_fma_f32 v162, v162, s60, -v244
    ds_read_b128 v[228:231], v26 offset:0
    v_mfma_f32_16x16x32_bf16 v[216:219], v[232:235], v[148:151], v[216:219]
    v_mfma_f32_16x16x32_bf16 v[12:15], v[8:11], v[148:151], v[12:15]
    v_fma_f32 v163, v163, s60, -v244
    v_exp_f32 v156, v156
    v_exp_f32 v157, v157
    ds_read_b128 v[232:235], v27 offset:0
    s_waitcnt lgkmcnt(8)
    v_mfma_f32_16x16x32_bf16 v[204:207], v[236:239], v[152:155], v[204:207]
    v_exp_f32 v158, v158
    v_exp_f32 v159, v159
    v_exp_f32 v160, v160
    ds_read_b128 v[236:239], v24 offset:256
    v_mfma_f32_16x16x32_bf16 v[208:211], v[240:243], v[152:155], v[208:211]
    v_exp_f32 v161, v161
    v_exp_f32 v162, v162
    v_exp_f32 v163, v163
    ds_read_b128 v[240:243], v25 offset:256
    s_waitcnt lgkmcnt(6)
    v_mfma_f32_16x16x32_bf16 v[212:215], v[0:3], v[152:155], v[212:215]
    v_cvt_pk_bf16_f32 v156, v156, v157
    v_cvt_pk_bf16_f32 v157, v158, v159
    v_cvt_pk_bf16_f32 v158, v160, v161
    ds_read_b128 v[0:3], v26 offset:256
    v_mfma_f32_16x16x32_bf16 v[216:219], v[4:7], v[152:155], v[216:219]
    v_mfma_f32_16x16x32_bf16 v[12:15], v[8:11], v[152:155], v[12:15]
    v_cvt_pk_bf16_f32 v159, v162, v163
    v_fma_f32 v164, v164, s60, -v244
    v_fma_f32 v165, v165, s60, -v244
    ds_read_b128 v[4:7], v27 offset:256
    s_waitcnt lgkmcnt(6)
    v_mfma_f32_16x16x32_bf16 v[172:175], v[220:223], v[28:31], 0
    v_fma_f32 v166, v166, s60, -v244
    v_fma_f32 v167, v167, s60, -v244
    v_fma_f32 v168, v168, s60, -v244
    ds_read_b128 v[220:223], v24 offset:8192
    v_mfma_f32_16x16x32_bf16 v[172:175], v[224:227], v[32:35], v[172:175]
    v_fma_f32 v169, v169, s60, -v244
    v_fma_f32 v170, v170, s60, -v244
    v_fma_f32 v171, v171, s60, -v244
    ds_read_b128 v[224:227], v25 offset:8192
    s_waitcnt lgkmcnt(6)
    v_mfma_f32_16x16x32_bf16 v[172:175], v[228:231], v[36:39], v[172:175]
    v_exp_f32 v164, v164
    v_exp_f32 v165, v165
    v_exp_f32 v166, v166
    ds_read_b128 v[228:231], v26 offset:8192
    v_mfma_f32_16x16x32_bf16 v[172:175], v[232:235], v[40:43], v[172:175]
    v_exp_f32 v167, v167
    v_exp_f32 v168, v168
    v_exp_f32 v169, v169
    ds_read_b128 v[232:235], v27 offset:8192
    s_waitcnt lgkmcnt(6)
    v_mfma_f32_16x16x32_bf16 v[172:175], v[236:239], v[44:47], v[172:175]
    v_exp_f32 v170, v170
    v_exp_f32 v171, v171
    v_cvt_pk_bf16_f32 v160, v164, v165
    ds_read_b128 v[236:239], v24 offset:8448
    v_mfma_f32_16x16x32_bf16 v[172:175], v[240:243], v[48:51], v[172:175]
    v_cvt_pk_bf16_f32 v161, v166, v167
    v_cvt_pk_bf16_f32 v162, v168, v169
    v_cvt_pk_bf16_f32 v163, v170, v171
    ds_read_b128 v[240:243], v25 offset:8448
    s_waitcnt lgkmcnt(6)
    v_mfma_f32_16x16x32_bf16 v[172:175], v[0:3], v[52:55], v[172:175]
    v_fma_f32 v188, v188, s60, -v244
    v_fma_f32 v189, v189, s60, -v244
    v_fma_f32 v190, v190, s60, -v244
    ds_read_b128 v[0:3], v26 offset:8448
    v_mfma_f32_16x16x32_bf16 v[172:175], v[4:7], v[56:59], v[172:175]
    v_fma_f32 v191, v191, s60, -v244
    v_fma_f32 v192, v192, s60, -v244
    v_fma_f32 v193, v193, s60, -v244
    ds_read_b128 v[4:7], v27 offset:8448
    s_waitcnt lgkmcnt(6)
    v_mfma_f32_16x16x32_bf16 v[176:179], v[220:223], v[28:31], 0
    v_fma_f32 v194, v194, s60, -v244
    v_fma_f32 v195, v195, s60, -v244
    v_exp_f32 v188, v188
    v_mov_b32 v24, v16
    v_mov_b32 v25, v17
    v_mov_b32 v26, v18
    v_mov_b32 v27, v19
    s_barrier
    ds_read_b128 v[220:223], v24 offset:0
    v_mfma_f32_16x16x32_bf16 v[176:179], v[224:227], v[32:35], v[176:179]
    v_exp_f32 v189, v189
    v_exp_f32 v190, v190
    v_exp_f32 v191, v191
    ds_read_b128 v[224:227], v25 offset:0
    s_waitcnt lgkmcnt(6)
    v_mfma_f32_16x16x32_bf16 v[176:179], v[228:231], v[36:39], v[176:179]
    v_exp_f32 v192, v192
    v_exp_f32 v193, v193
    v_exp_f32 v194, v194
    ds_read_b128 v[228:231], v26 offset:0
    v_mfma_f32_16x16x32_bf16 v[176:179], v[232:235], v[40:43], v[176:179]
    v_exp_f32 v195, v195
    v_cvt_pk_bf16_f32 v164, v188, v189
    v_cvt_pk_bf16_f32 v165, v190, v191
    ds_read_b128 v[232:235], v27 offset:0
    s_waitcnt lgkmcnt(6)
    v_mfma_f32_16x16x32_bf16 v[176:179], v[236:239], v[44:47], v[176:179]
    v_cvt_pk_bf16_f32 v166, v192, v193
    v_cvt_pk_bf16_f32 v167, v194, v195
    v_fma_f32 v196, v196, s60, -v244
    ds_read_b128 v[236:239], v24 offset:256
    v_mfma_f32_16x16x32_bf16 v[176:179], v[240:243], v[48:51], v[176:179]
    v_fma_f32 v197, v197, s60, -v244
    v_fma_f32 v198, v198, s60, -v244
    v_fma_f32 v199, v199, s60, -v244
    ds_read_b128 v[240:243], v25 offset:256
    s_waitcnt lgkmcnt(6)
    v_mfma_f32_16x16x32_bf16 v[176:179], v[0:3], v[52:55], v[176:179]
    v_fma_f32 v200, v200, s60, -v244
    v_fma_f32 v201, v201, s60, -v244
    v_fma_f32 v202, v202, s60, -v244
    ds_read_b128 v[0:3], v26 offset:256
    v_mfma_f32_16x16x32_bf16 v[176:179], v[4:7], v[56:59], v[176:179]
    v_fma_f32 v203, v203, s60, -v244
    v_exp_f32 v196, v196
    v_exp_f32 v197, v197
    ds_read_b128 v[4:7], v27 offset:256
    s_waitcnt lgkmcnt(6)
    v_mfma_f32_16x16x32_bf16 v[180:183], v[220:223], v[28:31], 0
    v_exp_f32 v198, v198
    v_exp_f32 v199, v199
    v_exp_f32 v200, v200
    ds_read_b128 v[220:223], v24 offset:8192
    v_mfma_f32_16x16x32_bf16 v[180:183], v[224:227], v[32:35], v[180:183]
    v_exp_f32 v201, v201
    v_exp_f32 v202, v202
    v_exp_f32 v203, v203
    ds_read_b128 v[224:227], v25 offset:8192
    s_waitcnt lgkmcnt(6)
    v_mfma_f32_16x16x32_bf16 v[180:183], v[228:231], v[36:39], v[180:183]
    v_cvt_pk_bf16_f32 v168, v196, v197
    v_cvt_pk_bf16_f32 v169, v198, v199
    v_cvt_pk_bf16_f32 v170, v200, v201
    ds_read_b128 v[228:231], v26 offset:8192
    v_mfma_f32_16x16x32_bf16 v[180:183], v[232:235], v[40:43], v[180:183]
    v_cvt_pk_bf16_f32 v171, v202, v203
    ds_read_b128 v[232:235], v27 offset:8192
    s_waitcnt lgkmcnt(6)
    v_mfma_f32_16x16x32_bf16 v[180:183], v[236:239], v[44:47], v[180:183]
    ds_read_b128 v[236:239], v24 offset:8448
    v_mfma_f32_16x16x32_bf16 v[180:183], v[240:243], v[48:51], v[180:183]
    ds_read_b128 v[240:243], v25 offset:8448
    s_waitcnt lgkmcnt(6)
    v_mfma_f32_16x16x32_bf16 v[180:183], v[0:3], v[52:55], v[180:183]
    ds_read_b128 v[0:3], v26 offset:8448
    v_mfma_f32_16x16x32_bf16 v[180:183], v[4:7], v[56:59], v[180:183]
    ds_read_b128 v[4:7], v27 offset:8448
    s_waitcnt lgkmcnt(6)
    v_mfma_f32_16x16x32_bf16 v[184:187], v[220:223], v[28:31], 0
    v_add_u32 v24, 16384, v16
    v_add_u32 v25, 16384, v17
    v_add_u32 v26, 16384, v18
    v_add_u32 v27, 16384, v19
    s_barrier
    ds_read_b128 v[220:223], v24 offset:0
    v_mfma_f32_16x16x32_bf16 v[184:187], v[224:227], v[32:35], v[184:187]
    ds_read_b128 v[224:227], v25 offset:0
    s_waitcnt lgkmcnt(6)
    v_mfma_f32_16x16x32_bf16 v[184:187], v[228:231], v[36:39], v[184:187]
    ds_read_b128 v[228:231], v26 offset:0
    v_mfma_f32_16x16x32_bf16 v[184:187], v[232:235], v[40:43], v[184:187]
    ds_read_b128 v[232:235], v27 offset:0
    s_waitcnt lgkmcnt(6)
    v_mfma_f32_16x16x32_bf16 v[184:187], v[236:239], v[44:47], v[184:187]
    ds_read_b128 v[236:239], v24 offset:256
    v_mfma_f32_16x16x32_bf16 v[184:187], v[240:243], v[48:51], v[184:187]
    ds_read_b128 v[240:243], v25 offset:256
    s_waitcnt lgkmcnt(6)
    v_mfma_f32_16x16x32_bf16 v[184:187], v[0:3], v[52:55], v[184:187]
    ds_read_b128 v[0:3], v26 offset:256
    v_mfma_f32_16x16x32_bf16 v[184:187], v[4:7], v[56:59], v[184:187]
    ds_read_b128 v[4:7], v27 offset:256
    s_nop 1
    s_waitcnt lgkmcnt(6)
    v_mfma_f32_16x16x32_bf16 v[188:191], v[220:223], v[28:31], 0
    ds_read_b128 v[220:223], v24 offset:8192
    v_mfma_f32_16x16x32_bf16 v[188:191], v[224:227], v[32:35], v[188:191]
    ds_read_b128 v[224:227], v25 offset:8192
    s_waitcnt lgkmcnt(6)
    v_mfma_f32_16x16x32_bf16 v[188:191], v[228:231], v[36:39], v[188:191]
    ds_read_b128 v[228:231], v26 offset:8192
    v_mfma_f32_16x16x32_bf16 v[188:191], v[232:235], v[40:43], v[188:191]
    ds_read_b128 v[232:235], v27 offset:8192
    s_waitcnt lgkmcnt(6)
    v_mfma_f32_16x16x32_bf16 v[188:191], v[236:239], v[44:47], v[188:191]
    ds_read_b128 v[236:239], v24 offset:8448
    v_mfma_f32_16x16x32_bf16 v[188:191], v[240:243], v[48:51], v[188:191]
    ds_read_b128 v[240:243], v25 offset:8448
    s_waitcnt lgkmcnt(6)
    v_mfma_f32_16x16x32_bf16 v[188:191], v[0:3], v[52:55], v[188:191]
    ds_read_b128 v[0:3], v26 offset:8448
    v_mfma_f32_16x16x32_bf16 v[188:191], v[4:7], v[56:59], v[188:191]
    ds_read_b128 v[4:7], v27 offset:8448
    s_waitcnt lgkmcnt(6)
    v_mfma_f32_16x16x32_bf16 v[192:195], v[220:223], v[28:31], 0
    v_add_u32 v24, 32768, v16
    v_add_u32 v25, 32768, v17
    v_add_u32 v26, 32768, v18
    v_add_u32 v27, 32768, v19
    s_barrier
    ds_read_b128 v[220:223], v24 offset:0
    v_mfma_f32_16x16x32_bf16 v[192:195], v[224:227], v[32:35], v[192:195]
    ds_read_b128 v[224:227], v25 offset:0
    s_waitcnt lgkmcnt(6)
    v_mfma_f32_16x16x32_bf16 v[192:195], v[228:231], v[36:39], v[192:195]
    ds_read_b128 v[228:231], v26 offset:0
    v_mfma_f32_16x16x32_bf16 v[192:195], v[232:235], v[40:43], v[192:195]
    ds_read_b128 v[232:235], v27 offset:0
    s_waitcnt lgkmcnt(6)
    v_mfma_f32_16x16x32_bf16 v[192:195], v[236:239], v[44:47], v[192:195]
    ds_read_b128 v[236:239], v24 offset:256
    v_mfma_f32_16x16x32_bf16 v[192:195], v[240:243], v[48:51], v[192:195]
    ds_read_b128 v[240:243], v25 offset:256
    s_waitcnt lgkmcnt(6)
    v_mfma_f32_16x16x32_bf16 v[192:195], v[0:3], v[52:55], v[192:195]
    ds_read_b128 v[0:3], v26 offset:256
    v_mfma_f32_16x16x32_bf16 v[192:195], v[4:7], v[56:59], v[192:195]
    ds_read_b128 v[4:7], v27 offset:256
    s_waitcnt lgkmcnt(6)
    v_mfma_f32_16x16x32_bf16 v[196:199], v[220:223], v[28:31], 0
    ds_read_b128 v[220:223], v24 offset:8192
    v_mfma_f32_16x16x32_bf16 v[196:199], v[224:227], v[32:35], v[196:199]
    ds_read_b128 v[224:227], v25 offset:8192
    s_waitcnt lgkmcnt(6)
    v_mfma_f32_16x16x32_bf16 v[196:199], v[228:231], v[36:39], v[196:199]
    ds_read_b128 v[228:231], v26 offset:8192
    v_mfma_f32_16x16x32_bf16 v[196:199], v[232:235], v[40:43], v[196:199]
    ds_read_b128 v[232:235], v27 offset:8192
    s_waitcnt lgkmcnt(6)
    v_mfma_f32_16x16x32_bf16 v[196:199], v[236:239], v[44:47], v[196:199]
    ds_read_b128 v[236:239], v24 offset:8448
    v_mfma_f32_16x16x32_bf16 v[196:199], v[240:243], v[48:51], v[196:199]
    ds_read_b128 v[240:243], v25 offset:8448
    s_waitcnt lgkmcnt(6)
    v_mfma_f32_16x16x32_bf16 v[196:199], v[0:3], v[52:55], v[196:199]
    ds_read_b128 v[0:3], v26 offset:8448
    v_mfma_f32_16x16x32_bf16 v[196:199], v[4:7], v[56:59], v[196:199]
    ds_read_b128 v[4:7], v27 offset:8448
    s_waitcnt lgkmcnt(6)
    v_mfma_f32_16x16x32_bf16 v[200:203], v[220:223], v[28:31], 0
    v_add_u32 v24, 49152, v20
    v_add_u32 v25, 49152, v21
    v_add_u32 v26, 49152, v22
    v_add_u32 v27, 49152, v23
    s_barrier
    ds_read_b64_tr_b16 v[220:221], v24 offset:0
    ds_read_b64_tr_b16 v[222:223], v24 offset:2048
    v_mfma_f32_16x16x32_bf16 v[200:203], v[224:227], v[32:35], v[200:203]
    ds_read_b64_tr_b16 v[224:225], v25 offset:0
    ds_read_b64_tr_b16 v[226:227], v25 offset:2048
    s_waitcnt lgkmcnt(8)
    v_mfma_f32_16x16x32_bf16 v[200:203], v[228:231], v[36:39], v[200:203]
    ds_read_b64_tr_b16 v[228:229], v26 offset:0
    ds_read_b64_tr_b16 v[230:231], v26 offset:2048
    v_mfma_f32_16x16x32_bf16 v[200:203], v[232:235], v[40:43], v[200:203]
    ds_read_b64_tr_b16 v[232:233], v27 offset:0
    ds_read_b64_tr_b16 v[234:235], v27 offset:2048
    s_waitcnt lgkmcnt(10)
    v_mfma_f32_16x16x32_bf16 v[200:203], v[236:239], v[44:47], v[200:203]
    ds_read_b64_tr_b16 v[236:237], v24 offset:4096
    ds_read_b64_tr_b16 v[238:239], v24 offset:6144
    v_mfma_f32_16x16x32_bf16 v[200:203], v[240:243], v[48:51], v[200:203]
    ds_read_b64_tr_b16 v[240:241], v25 offset:4096
    ds_read_b64_tr_b16 v[242:243], v25 offset:6144
    s_waitcnt lgkmcnt(12)
    v_mfma_f32_16x16x32_bf16 v[200:203], v[0:3], v[52:55], v[200:203]
    ds_read_b64_tr_b16 v[0:1], v26 offset:4096
    ds_read_b64_tr_b16 v[2:3], v26 offset:6144
    v_mfma_f32_16x16x32_bf16 v[200:203], v[4:7], v[56:59], v[200:203]
    v_max3_f32 v253, v172, v173, v174
    v_max3_f32 v253, v175, v176, v253
    v_max3_f32 v253, v177, v178, v253
    s_nop 7
    v_mul_f32 v204, v204, v251
    v_mul_f32 v205, v205, v251
    v_mul_f32 v206, v206, v251
    v_mul_f32 v207, v207, v251
    v_mul_f32 v208, v208, v251
    v_mul_f32 v209, v209, v251
    v_mul_f32 v210, v210, v251
    v_mul_f32 v211, v211, v251
    v_mul_f32 v212, v212, v251
    v_mul_f32 v213, v213, v251
    v_mul_f32 v214, v214, v251
    v_mul_f32 v215, v215, v251
    v_mul_f32 v216, v216, v251
    v_mul_f32 v217, v217, v251
    v_mul_f32 v218, v218, v251
    v_mul_f32 v219, v219, v251
    v_mul_f32 v12, v12, v251
    v_mul_f32 v13, v13, v251
    v_mul_f32 v14, v14, v251
    v_mul_f32 v15, v15, v251
    s_nop 0
    s_waitcnt lgkmcnt(10)
    v_mfma_f32_16x16x32_bf16 v[204:207], v[220:223], v[156:159], v[204:207]
    v_max_f32 v253, v179, v253
    v_max3_f32 v253, v180, v181, v253
    v_max3_f32 v253, v182, v183, v253
    ds_read_b64_tr_b16 v[4:5], v27 offset:4096
    ds_read_b64_tr_b16 v[6:7], v27 offset:6144
    ds_read_b64_tr_b16 v[220:221], v24 offset:8192
    ds_read_b64_tr_b16 v[222:223], v24 offset:10240
    v_mfma_f32_16x16x32_bf16 v[208:211], v[224:227], v[156:159], v[208:211]
    v_max3_f32 v253, v184, v185, v253
    v_max3_f32 v253, v186, v187, v253
    v_max3_f32 v253, v188, v189, v253
    s_waitcnt lgkmcnt(10)
    v_mfma_f32_16x16x32_bf16 v[212:215], v[228:231], v[156:159], v[212:215]
    v_max3_f32 v253, v190, v191, v253
    v_max3_f32 v253, v192, v193, v253
    v_max3_f32 v253, v194, v195, v253
    ds_read_b64_tr_b16 v[224:225], v25 offset:8192
    ds_read_b64_tr_b16 v[226:227], v25 offset:10240
    ds_read_b64_tr_b16 v[228:229], v26 offset:8192
    ds_read_b64_tr_b16 v[230:231], v26 offset:10240
    v_mfma_f32_16x16x32_bf16 v[216:219], v[232:235], v[156:159], v[216:219]
    v_mfma_f32_16x16x32_bf16 v[12:15], v[8:11], v[156:159], v[12:15]
    v_max3_f32 v253, v196, v197, v253
    v_max3_f32 v253, v198, v199, v253
    v_max3_f32 v253, v200, v201, v253
    s_waitcnt lgkmcnt(10)
    v_mfma_f32_16x16x32_bf16 v[204:207], v[236:239], v[160:163], v[204:207]
    v_max3_f32 v253, v202, v203, v253
    v_mul_f32 v253, s60, v253
    v_mov_b32 v254, v253
    ds_read_b64_tr_b16 v[232:233], v27 offset:8192
    ds_read_b64_tr_b16 v[234:235], v27 offset:10240
    ds_read_b64_tr_b16 v[236:237], v24 offset:12288
    ds_read_b64_tr_b16 v[238:239], v24 offset:14336
    v_mfma_f32_16x16x32_bf16 v[208:211], v[240:243], v[160:163], v[208:211]
    s_nop 1
    v_permlane16_swap_b32 v253, v254
    v_max_f32 v253, v253, v254
    s_waitcnt lgkmcnt(10)
    v_mfma_f32_16x16x32_bf16 v[212:215], v[0:3], v[160:163], v[212:215]
    v_mov_b32 v254, v253
    s_nop 1
    v_permlane32_swap_b32 v253, v254
    ds_read_b64_tr_b16 v[240:241], v25 offset:12288
    ds_read_b64_tr_b16 v[242:243], v25 offset:14336
    ds_read_b64_tr_b16 v[0:1], v26 offset:12288
    ds_read_b64_tr_b16 v[2:3], v26 offset:14336
    v_mfma_f32_16x16x32_bf16 v[216:219], v[4:7], v[160:163], v[216:219]
    v_mfma_f32_16x16x32_bf16 v[12:15], v[8:11], v[160:163], v[12:15]
    v_max_f32 v253, v253, v254
    v_max_f32 v253, v253, v244
    v_sub_f32 v252, v244, v253
    s_waitcnt lgkmcnt(10)
    v_mfma_f32_16x16x32_bf16 v[204:207], v[220:223], v[164:167], v[204:207]
    v_exp_f32 v252, v252
    v_mov_b32 v244, v253
    v_fma_f32 v172, v172, s60, -v244
    ds_read_b64_tr_b16 v[4:5], v27 offset:12288
    ds_read_b64_tr_b16 v[6:7], v27 offset:14336
    v_add_u32 v24, 65536, v20
    v_add_u32 v25, 65536, v21
    v_add_u32 v26, 65536, v22
    v_add_u32 v27, 65536, v23
    s_barrier
    ds_read_b64_tr_b16 v[220:221], v24 offset:0
    ds_read_b64_tr_b16 v[222:223], v24 offset:2048
    v_mfma_f32_16x16x32_bf16 v[208:211], v[224:227], v[164:167], v[208:211]
    v_fma_f32 v173, v173, s60, -v244
    v_fma_f32 v174, v174, s60, -v244
    v_fma_f32 v175, v175, s60, -v244
    s_waitcnt lgkmcnt(10)
    v_mfma_f32_16x16x32_bf16 v[212:215], v[228:231], v[164:167], v[212:215]
    v_fma_f32 v176, v176, s60, -v244
    v_fma_f32 v177, v177, s60, -v244
    v_fma_f32 v178, v178, s60, -v244
    ds_read_b64_tr_b16 v[224:225], v25 offset:0
    ds_read_b64_tr_b16 v[226:227], v25 offset:2048
    ds_read_b64_tr_b16 v[228:229], v26 offset:0
    ds_read_b64_tr_b16 v[230:231], v26 offset:2048
    v_mfma_f32_16x16x32_bf16 v[216:219], v[232:235], v[164:167], v[216:219]
    v_mfma_f32_16x16x32_bf16 v[12:15], v[8:11], v[164:167], v[12:15]
    v_fma_f32 v179, v179, s60, -v244
    v_exp_f32 v172, v172
    v_exp_f32 v173, v173
    s_waitcnt lgkmcnt(10)
    v_mfma_f32_16x16x32_bf16 v[204:207], v[236:239], v[168:171], v[204:207]
    v_exp_f32 v174, v174
    v_exp_f32 v175, v175
    v_exp_f32 v176, v176
    ds_read_b64_tr_b16 v[232:233], v27 offset:0
    ds_read_b64_tr_b16 v[234:235], v27 offset:2048
    ds_read_b64_tr_b16 v[236:237], v24 offset:4096
    ds_read_b64_tr_b16 v[238:239], v24 offset:6144
    v_mfma_f32_16x16x32_bf16 v[208:211], v[240:243], v[168:171], v[208:211]
    v_exp_f32 v177, v177
    v_exp_f32 v178, v178
    v_exp_f32 v179, v179
    s_waitcnt lgkmcnt(10)
    v_mfma_f32_16x16x32_bf16 v[212:215], v[0:3], v[168:171], v[212:215]
    v_cvt_pk_bf16_f32 v172, v172, v173
    v_cvt_pk_bf16_f32 v173, v174, v175
    v_cvt_pk_bf16_f32 v174, v176, v177
    ds_read_b64_tr_b16 v[240:241], v25 offset:4096
    ds_read_b64_tr_b16 v[242:243], v25 offset:6144
    ds_read_b64_tr_b16 v[0:1], v26 offset:4096
    ds_read_b64_tr_b16 v[2:3], v26 offset:6144
    v_mfma_f32_16x16x32_bf16 v[216:219], v[4:7], v[168:171], v[216:219]
    v_mfma_f32_16x16x32_bf16 v[12:15], v[8:11], v[168:171], v[12:15]
    v_cvt_pk_bf16_f32 v175, v178, v179
    v_fma_f32 v180, v180, s60, -v244
    v_fma_f32 v181, v181, s60, -v244
    v_fma_f32 v182, v182, s60, -v244
    v_fma_f32 v183, v183, s60, -v244
    v_fma_f32 v184, v184, s60, -v244
    v_fma_f32 v185, v185, s60, -v244
    v_fma_f32 v186, v186, s60, -v244
    v_fma_f32 v187, v187, s60, -v244
    v_exp_f32 v180, v180
    v_exp_f32 v181, v181
    v_exp_f32 v182, v182
    v_exp_f32 v183, v183
    v_exp_f32 v184, v184
    v_exp_f32 v185, v185
    v_exp_f32 v186, v186
    v_exp_f32 v187, v187
    v_cvt_pk_bf16_f32 v176, v180, v181
    v_cvt_pk_bf16_f32 v177, v182, v183
    v_cvt_pk_bf16_f32 v178, v184, v185
    v_cvt_pk_bf16_f32 v179, v186, v187
    v_fma_f32 v188, v188, s60, -v244
    v_fma_f32 v189, v189, s60, -v244
    v_fma_f32 v190, v190, s60, -v244
    v_fma_f32 v191, v191, s60, -v244
    v_fma_f32 v192, v192, s60, -v244
    v_fma_f32 v193, v193, s60, -v244
    v_fma_f32 v194, v194, s60, -v244
    v_fma_f32 v195, v195, s60, -v244
    v_exp_f32 v188, v188
    v_exp_f32 v189, v189
    v_exp_f32 v190, v190
    v_exp_f32 v191, v191
    v_exp_f32 v192, v192
    v_exp_f32 v193, v193
    v_exp_f32 v194, v194
    v_exp_f32 v195, v195
    v_cvt_pk_bf16_f32 v180, v188, v189
    v_cvt_pk_bf16_f32 v181, v190, v191
    v_cvt_pk_bf16_f32 v182, v192, v193
    v_cvt_pk_bf16_f32 v183, v194, v195
    v_fma_f32 v196, v196, s60, -v244
    v_fma_f32 v197, v197, s60, -v244
    v_fma_f32 v198, v198, s60, -v244
    v_fma_f32 v199, v199, s60, -v244
    v_fma_f32 v200, v200, s60, -v244
    v_fma_f32 v201, v201, s60, -v244
    v_fma_f32 v202, v202, s60, -v244
    v_fma_f32 v203, v203, s60, -v244
    v_exp_f32 v196, v196
    v_exp_f32 v197, v197
    v_exp_f32 v198, v198
    v_exp_f32 v199, v199
    v_exp_f32 v200, v200
    v_exp_f32 v201, v201
    v_exp_f32 v202, v202
    v_exp_f32 v203, v203
    v_cvt_pk_bf16_f32 v184, v196, v197
    v_cvt_pk_bf16_f32 v185, v198, v199
    v_cvt_pk_bf16_f32 v186, v200, v201
    v_cvt_pk_bf16_f32 v187, v202, v203
    s_nop 1
    s_nop 7
    v_mul_f32 v204, v204, v252
    v_mul_f32 v205, v205, v252
    v_mul_f32 v206, v206, v252
    v_mul_f32 v207, v207, v252
    v_mul_f32 v208, v208, v252
    v_mul_f32 v209, v209, v252
    v_mul_f32 v210, v210, v252
    v_mul_f32 v211, v211, v252
    v_mul_f32 v212, v212, v252
    v_mul_f32 v213, v213, v252
    v_mul_f32 v214, v214, v252
    v_mul_f32 v215, v215, v252
    v_mul_f32 v216, v216, v252
    v_mul_f32 v217, v217, v252
    v_mul_f32 v218, v218, v252
    v_mul_f32 v219, v219, v252
    v_mul_f32 v12, v12, v252
    v_mul_f32 v13, v13, v252
    v_mul_f32 v14, v14, v252
    v_mul_f32 v15, v15, v252
    s_nop 0
    s_waitcnt lgkmcnt(10)
    v_mfma_f32_16x16x32_bf16 v[204:207], v[220:223], v[172:175], v[204:207]
    ds_read_b64_tr_b16 v[4:5], v27 offset:4096
    ds_read_b64_tr_b16 v[6:7], v27 offset:6144
    ds_read_b64_tr_b16 v[220:221], v24 offset:8192
    ds_read_b64_tr_b16 v[222:223], v24 offset:10240
    v_mfma_f32_16x16x32_bf16 v[208:211], v[224:227], v[172:175], v[208:211]
    s_waitcnt lgkmcnt(10)
    v_mfma_f32_16x16x32_bf16 v[212:215], v[228:231], v[172:175], v[212:215]
    ds_read_b64_tr_b16 v[224:225], v25 offset:8192
    ds_read_b64_tr_b16 v[226:227], v25 offset:10240
    ds_read_b64_tr_b16 v[228:229], v26 offset:8192
    ds_read_b64_tr_b16 v[230:231], v26 offset:10240
    v_mfma_f32_16x16x32_bf16 v[216:219], v[232:235], v[172:175], v[216:219]
    v_mfma_f32_16x16x32_bf16 v[12:15], v[8:11], v[172:175], v[12:15]
    s_waitcnt lgkmcnt(10)
    v_mfma_f32_16x16x32_bf16 v[204:207], v[236:239], v[176:179], v[204:207]
    ds_read_b64_tr_b16 v[232:233], v27 offset:8192
    ds_read_b64_tr_b16 v[234:235], v27 offset:10240
    ds_read_b64_tr_b16 v[236:237], v24 offset:12288
    ds_read_b64_tr_b16 v[238:239], v24 offset:14336
    v_mfma_f32_16x16x32_bf16 v[208:211], v[240:243], v[176:179], v[208:211]
    s_waitcnt lgkmcnt(10)
    v_mfma_f32_16x16x32_bf16 v[212:215], v[0:3], v[176:179], v[212:215]
    ds_read_b64_tr_b16 v[240:241], v25 offset:12288
    ds_read_b64_tr_b16 v[242:243], v25 offset:14336
    ds_read_b64_tr_b16 v[0:1], v26 offset:12288
    ds_read_b64_tr_b16 v[2:3], v26 offset:14336
    v_mfma_f32_16x16x32_bf16 v[216:219], v[4:7], v[176:179], v[216:219]
    v_mfma_f32_16x16x32_bf16 v[12:15], v[8:11], v[176:179], v[12:15]
    s_waitcnt lgkmcnt(10)
    v_mfma_f32_16x16x32_bf16 v[204:207], v[220:223], v[180:183], v[204:207]
    ds_read_b64_tr_b16 v[4:5], v27 offset:12288
    ds_read_b64_tr_b16 v[6:7], v27 offset:14336
    v_add_u32 v24, 81920, v16
    v_add_u32 v25, 81920, v17
    v_add_u32 v26, 81920, v18
    v_add_u32 v27, 81920, v19
    s_barrier
    ds_read_b128 v[220:223], v24 offset:0
    v_mfma_f32_16x16x32_bf16 v[208:211], v[224:227], v[180:183], v[208:211]
    ds_read_b128 v[224:227], v25 offset:0
    s_waitcnt lgkmcnt(10)
    v_mfma_f32_16x16x32_bf16 v[212:215], v[228:231], v[180:183], v[212:215]
    ds_read_b128 v[228:231], v26 offset:0
    v_mfma_f32_16x16x32_bf16 v[216:219], v[232:235], v[180:183], v[216:219]
    v_mfma_f32_16x16x32_bf16 v[12:15], v[8:11], v[180:183], v[12:15]
    ds_read_b128 v[232:235], v27 offset:0
    s_waitcnt lgkmcnt(8)
    v_mfma_f32_16x16x32_bf16 v[204:207], v[236:239], v[184:187], v[204:207]
    ds_read_b128 v[236:239], v24 offset:256
    v_mfma_f32_16x16x32_bf16 v[208:211], v[240:243], v[184:187], v[208:211]
    ds_read_b128 v[240:243], v25 offset:256
    s_waitcnt lgkmcnt(6)
    v_mfma_f32_16x16x32_bf16 v[212:215], v[0:3], v[184:187], v[212:215]
    ds_read_b128 v[0:3], v26 offset:256
    v_mfma_f32_16x16x32_bf16 v[216:219], v[4:7], v[184:187], v[216:219]
    v_mfma_f32_16x16x32_bf16 v[12:15], v[8:11], v[184:187], v[12:15]
    v_mbcnt_lo_u32_b32 v253, -1, 0
    v_mbcnt_hi_u32_b32 v253, -1, v253
    v_lshlrev_b32 v254, 4, v253
    v_lshlrev_b32 v255, 3, v253
    s_nop 4
    v_mov_b32 v245, v12
    buffer_store_dwordx4 v[204:207], v254, s[48:51], s65 offen offset:0 sc1
    buffer_store_dwordx4 v[208:211], v254, s[48:51], s65 offen offset:1024 sc1
    buffer_store_dwordx4 v[212:215], v254, s[48:51], s65 offen offset:2048 sc1
    buffer_store_dwordx4 v[216:219], v254, s[48:51], s65 offen offset:3072 sc1
    buffer_store_dwordx2 v[244:245], v255, s[48:51], s66 offen sc1
    v_and_b32 v254, 15, v253
    v_lshrrev_b32 v253, 4, v253
    v_lshlrev_b32 v253, 3, v253
    v_lshl_add_u32 v253, v254, 6, v253
    buffer_load_dwordx2 v[212:213], v253, s[40:43], s69 offen
    buffer_load_dwordx2 v[214:215], v253, s[40:43], s69 offen offset:32
    ds_read_b128 v[4:7], v27 offset:256
    s_waitcnt lgkmcnt(6)
    v_mfma_f32_16x16x32_bf16 v[204:207], v[220:223], v[28:31], 0
    ds_read_b128 v[220:223], v24 offset:8192
    v_mfma_f32_16x16x32_bf16 v[204:207], v[224:227], v[32:35], v[204:207]
    ds_read_b128 v[224:227], v25 offset:8192
    s_waitcnt lgkmcnt(6)
    v_mfma_f32_16x16x32_bf16 v[204:207], v[228:231], v[36:39], v[204:207]
    ds_read_b128 v[228:231], v26 offset:8192
    v_mfma_f32_16x16x32_bf16 v[204:207], v[232:235], v[40:43], v[204:207]
    ds_read_b128 v[232:235], v27 offset:8192
    s_waitcnt lgkmcnt(6)
    v_mfma_f32_16x16x32_bf16 v[204:207], v[236:239], v[44:47], v[204:207]
    ds_read_b128 v[236:239], v24 offset:8448
    v_mfma_f32_16x16x32_bf16 v[204:207], v[240:243], v[48:51], v[204:207]
    ds_read_b128 v[240:243], v25 offset:8448
    s_waitcnt lgkmcnt(6)
    v_mfma_f32_16x16x32_bf16 v[204:207], v[0:3], v[52:55], v[204:207]
    ds_read_b128 v[0:3], v26 offset:8448
    v_mfma_f32_16x16x32_bf16 v[204:207], v[4:7], v[56:59], v[204:207]
    ds_read_b128 v[4:7], v27 offset:8448
    s_waitcnt lgkmcnt(6)
    v_mfma_f32_16x16x32_bf16 v[208:211], v[220:223], v[28:31], 0
    v_add_u32 v24, 98304, v20
    v_add_u32 v25, 98304, v21
    v_add_u32 v26, 98304, v22
    v_add_u32 v27, 98304, v23
    s_barrier
    ds_read_b64_tr_b16 v[220:221], v24 offset:0
    ds_read_b64_tr_b16 v[222:223], v24 offset:2048
    v_mfma_f32_16x16x32_bf16 v[208:211], v[224:227], v[32:35], v[208:211]
    ds_read_b64_tr_b16 v[224:225], v25 offset:0
    ds_read_b64_tr_b16 v[226:227], v25 offset:2048
    s_waitcnt lgkmcnt(8)
    v_mfma_f32_16x16x32_bf16 v[208:211], v[228:231], v[36:39], v[208:211]
    ds_read_b64_tr_b16 v[228:229], v26 offset:0
    ds_read_b64_tr_b16 v[230:231], v26 offset:2048
    v_mfma_f32_16x16x32_bf16 v[208:211], v[232:235], v[40:43], v[208:211]
    ds_read_b64_tr_b16 v[232:233], v27 offset:0
    ds_read_b64_tr_b16 v[234:235], v27 offset:2048
    s_waitcnt lgkmcnt(10)
    v_mfma_f32_16x16x32_bf16 v[208:211], v[236:239], v[44:47], v[208:211]
    ds_read_b64_tr_b16 v[236:237], v24 offset:4096
    ds_read_b64_tr_b16 v[238:239], v24 offset:6144
    v_mfma_f32_16x16x32_bf16 v[208:211], v[240:243], v[48:51], v[208:211]
    ds_read_b64_tr_b16 v[240:241], v25 offset:4096
    ds_read_b64_tr_b16 v[242:243], v25 offset:6144
    s_waitcnt lgkmcnt(12)
    v_mfma_f32_16x16x32_bf16 v[208:211], v[0:3], v[52:55], v[208:211]
    ds_read_b64_tr_b16 v[0:1], v26 offset:4096
    ds_read_b64_tr_b16 v[2:3], v26 offset:6144
    v_mfma_f32_16x16x32_bf16 v[208:211], v[4:7], v[56:59], v[208:211]
    s_waitcnt vmcnt(0)
    v_mov_b32 v253, 114688
    v_mov_b32 v254, 1
    s_mov_b64 exec, 1
    ds_add_rtn_u32 v255, v253, v254
    s_waitcnt lgkmcnt(0)
    v_readfirstlane_b32 s72, v255
    s_lshl_b32 s73, 1, s71
    s_nop 0
    s_nop 1
    s_cmp_lg_u32 s72, 3
    s_cbranch_scc1 L_nosig
    v_mov_b32 v253, s74
    v_mov_b32 v254, s73
    buffer_atomic_add v254, v253, s[52:55], 0 offen sc1
L_nosig:
    s_mov_b64 exec, -1
    v_lshlrev_b32 v36, 16, v212
    v_sub_f32 v36, 1.0, v36
    v_mul_f32 v36, s61, v36
    ds_read_b64_tr_b16 v[4:5], v27 offset:4096
    ds_read_b64_tr_b16 v[6:7], v27 offset:6144
    v_mfma_f32_16x16x32_bf16 v[188:191], v[220:223], v[60:63], 0
    v_and_b32 v37, 0xffff0000, v212
    v_sub_f32 v37, 1.0, v37
    v_mul_f32 v37, s61, v37
    ds_read_b64_tr_b16 v[220:221], v24 offset:8192
    ds_read_b64_tr_b16 v[222:223], v24 offset:10240
    v_mfma_f32_16x16x32_bf16 v[192:195], v[224:227], v[60:63], 0
    v_lshlrev_b32 v38, 16, v213
    v_sub_f32 v38, 1.0, v38
    v_mul_f32 v38, s61, v38
    ds_read_b64_tr_b16 v[224:225], v25 offset:8192
    ds_read_b64_tr_b16 v[226:227], v25 offset:10240
    v_mfma_f32_16x16x32_bf16 v[196:199], v[228:231], v[60:63], 0
    v_and_b32 v39, 0xffff0000, v213
    v_sub_f32 v39, 1.0, v39
    v_mul_f32 v39, s61, v39
    ds_read_b64_tr_b16 v[228:229], v26 offset:8192
    ds_read_b64_tr_b16 v[230:231], v26 offset:10240
    v_mfma_f32_16x16x32_bf16 v[200:203], v[232:235], v[60:63], 0
    v_lshlrev_b32 v40, 16, v214
    v_sub_f32 v40, 1.0, v40
    v_mul_f32 v40, s61, v40
    ds_read_b64_tr_b16 v[232:233], v27 offset:8192
    ds_read_b64_tr_b16 v[234:235], v27 offset:10240
    v_mfma_f32_16x16x32_bf16 v[188:191], v[236:239], v[64:67], v[188:191]
    v_and_b32 v41, 0xffff0000, v214
    v_sub_f32 v41, 1.0, v41
    v_mul_f32 v41, s61, v41
    ds_read_b64_tr_b16 v[236:237], v24 offset:12288
    ds_read_b64_tr_b16 v[238:239], v24 offset:14336
    v_mfma_f32_16x16x32_bf16 v[192:195], v[240:243], v[64:67], v[192:195]
    v_lshlrev_b32 v42, 16, v215
    v_sub_f32 v42, 1.0, v42
    v_mul_f32 v42, s61, v42
    ds_read_b64_tr_b16 v[240:241], v25 offset:12288
    ds_read_b64_tr_b16 v[242:243], v25 offset:14336
    v_mfma_f32_16x16x32_bf16 v[196:199], v[0:3], v[64:67], v[196:199]
    v_and_b32 v43, 0xffff0000, v215
    v_sub_f32 v43, 1.0, v43
    v_mul_f32 v43, s61, v43
    s_waitcnt lgkmcnt(10)
    v_mfma_f32_16x16x32_bf16 v[200:203], v[4:7], v[64:67], v[200:203]
    v_fma_f32 v204, v204, s60, v36
    v_fma_f32 v205, v205, s60, v37
    v_fma_f32 v206, v206, s60, v38
    ds_read_b64_tr_b16 v[0:1], v26 offset:12288
    ds_read_b64_tr_b16 v[2:3], v26 offset:14336
    ds_read_b64_tr_b16 v[4:5], v27 offset:12288
    ds_read_b64_tr_b16 v[6:7], v27 offset:14336
    v_mfma_f32_16x16x32_bf16 v[188:191], v[220:223], v[68:71], v[188:191]
    v_fma_f32 v207, v207, s60, v39
    v_fma_f32 v208, v208, s60, v40
    v_fma_f32 v209, v209, s60, v41
    s_waitcnt lgkmcnt(10)
    v_mfma_f32_16x16x32_bf16 v[192:195], v[224:227], v[68:71], v[192:195]
    v_fma_f32 v210, v210, s60, v42
    v_fma_f32 v211, v211, s60, v43
    v_max3_f32 v253, v204, v205, v206
    v_mov_b32 v24, v20
    v_mov_b32 v25, v21
    v_mov_b32 v26, v22
    v_mov_b32 v27, v23
    s_barrier
    ds_read_b64_tr_b16 v[220:221], v24 offset:0
    ds_read_b64_tr_b16 v[222:223], v24 offset:2048
    ds_read_b64_tr_b16 v[224:225], v25 offset:0
    ds_read_b64_tr_b16 v[226:227], v25 offset:2048
    v_mfma_f32_16x16x32_bf16 v[196:199], v[228:231], v[68:71], v[196:199]
    v_max3_f32 v253, v207, v208, v253
    v_max3_f32 v253, v209, v210, v253
    v_max_f32 v253, v211, v253
    s_waitcnt lgkmcnt(10)
    v_mfma_f32_16x16x32_bf16 v[200:203], v[232:235], v[68:71], v[200:203]
    v_mov_b32 v254, v253
    s_nop 1
    v_permlane16_swap_b32 v253, v254
    ds_read_b64_tr_b16 v[228:229], v26 offset:0
    ds_read_b64_tr_b16 v[230:231], v26 offset:2048
    ds_read_b64_tr_b16 v[232:233], v27 offset:0
    ds_read_b64_tr_b16 v[234:235], v27 offset:2048
    v_mfma_f32_16x16x32_bf16 v[188:191], v[236:239], v[72:75], v[188:191]
    v_max_f32 v253, v253, v254
    v_mov_b32 v254, v253
    s_nop 1
    s_waitcnt lgkmcnt(10)
    v_mfma_f32_16x16x32_bf16 v[192:195], v[240:243], v[72:75], v[192:195]
    v_permlane32_swap_b32 v253, v254
    v_max_f32 v253, v253, v254
    v_max_f32 v253, v253, v244
    ds_read_b64_tr_b16 v[236:237], v24 offset:4096
    ds_read_b64_tr_b16 v[238:239], v24 offset:6144
    ds_read_b64_tr_b16 v[240:241], v25 offset:4096
    ds_read_b64_tr_b16 v[242:243], v25 offset:6144
    v_mfma_f32_16x16x32_bf16 v[196:199], v[0:3], v[72:75], v[196:199]
    v_sub_f32 v52, v244, v253
    v_exp_f32 v52, v52
    v_mov_b32 v244, v253
    s_waitcnt lgkmcnt(10)
    v_mfma_f32_16x16x32_bf16 v[200:203], v[4:7], v[72:75], v[200:203]
    v_sub_f32 v204, v204, v244
    v_sub_f32 v205, v205, v244
    v_sub_f32 v206, v206, v244
    ds_read_b64_tr_b16 v[0:1], v26 offset:4096
    ds_read_b64_tr_b16 v[2:3], v26 offset:6144
    ds_read_b64_tr_b16 v[4:5], v27 offset:4096
    ds_read_b64_tr_b16 v[6:7], v27 offset:6144
    s_nop 7
    v_mul_f32 v188, v188, v246
    v_mul_f32 v189, v189, v246
    v_mul_f32 v190, v190, v246
    v_mul_f32 v191, v191, v246
    v_mul_f32 v192, v192, v246
    v_mul_f32 v193, v193, v246
    v_mul_f32 v194, v194, v246
    v_mul_f32 v195, v195, v246
    v_mul_f32 v196, v196, v246
    v_mul_f32 v197, v197, v246
    v_mul_f32 v198, v198, v246
    v_mul_f32 v199, v199, v246
    v_mul_f32 v200, v200, v246
    v_mul_f32 v201, v201, v246
    v_mul_f32 v202, v202, v246
    v_mul_f32 v203, v203, v246
    s_nop 0
    v_mfma_f32_16x16x32_bf16 v[188:191], v[220:223], v[92:95], v[188:191]
    v_sub_f32 v207, v207, v244
    v_sub_f32 v208, v208, v244
    v_sub_f32 v209, v209, v244
    s_waitcnt lgkmcnt(10)
    v_mfma_f32_16x16x32_bf16 v[192:195], v[224:227], v[92:95], v[192:195]
    v_sub_f32 v210, v210, v244
    v_sub_f32 v211, v211, v244
    v_exp_f32 v204, v204
    ds_read_b64_tr_b16 v[220:221], v24 offset:8192
    ds_read_b64_tr_b16 v[222:223], v24 offset:10240
    ds_read_b64_tr_b16 v[224:225], v25 offset:8192
    ds_read_b64_tr_b16 v[226:227], v25 offset:10240
    v_mfma_f32_16x16x32_bf16 v[196:199], v[228:231], v[92:95], v[196:199]
    v_exp_f32 v205, v205
    v_exp_f32 v206, v206
    v_exp_f32 v207, v207
    s_waitcnt lgkmcnt(10)
    v_mfma_f32_16x16x32_bf16 v[200:203], v[232:235], v[92:95], v[200:203]
    v_exp_f32 v208, v208
    v_exp_f32 v209, v209
    v_exp_f32 v210, v210
    ds_read_b64_tr_b16 v[228:229], v26 offset:8192
    ds_read_b64_tr_b16 v[230:231], v26 offset:10240
    ds_read_b64_tr_b16 v[232:233], v27 offset:8192
    ds_read_b64_tr_b16 v[234:235], v27 offset:10240
    v_mfma_f32_16x16x32_bf16 v[188:191], v[236:239], v[96:99], v[188:191]
    v_exp_f32 v211, v211
    v_cvt_pk_bf16_f32 v48, v204, v205
    v_cvt_pk_bf16_f32 v49, v206, v207
    s_waitcnt lgkmcnt(10)
    v_mfma_f32_16x16x32_bf16 v[192:195], v[240:243], v[96:99], v[192:195]
    v_cvt_pk_bf16_f32 v50, v208, v209
    v_cvt_pk_bf16_f32 v51, v210, v211
    ds_read_b64_tr_b16 v[236:237], v24 offset:12288
    ds_read_b64_tr_b16 v[238:239], v24 offset:14336
    ds_read_b64_tr_b16 v[240:241], v25 offset:12288
    ds_read_b64_tr_b16 v[242:243], v25 offset:14336
    v_mfma_f32_16x16x32_bf16 v[196:199], v[0:3], v[96:99], v[196:199]
    s_waitcnt lgkmcnt(10)
    v_mfma_f32_16x16x32_bf16 v[200:203], v[4:7], v[96:99], v[200:203]
    ds_read_b64_tr_b16 v[0:1], v26 offset:12288
    ds_read_b64_tr_b16 v[2:3], v26 offset:14336
    ds_read_b64_tr_b16 v[4:5], v27 offset:12288
    ds_read_b64_tr_b16 v[6:7], v27 offset:14336
    v_mfma_f32_16x16x32_bf16 v[188:191], v[220:223], v[100:103], v[188:191]
    s_waitcnt lgkmcnt(10)
    v_mfma_f32_16x16x32_bf16 v[192:195], v[224:227], v[100:103], v[192:195]
    v_add_u32 v24, 16384, v20
    v_add_u32 v25, 16384, v21
    v_add_u32 v26, 16384, v22
    v_add_u32 v27, 16384, v23
    s_barrier
    ds_read_b64_tr_b16 v[220:221], v24 offset:0
    ds_read_b64_tr_b16 v[222:223], v24 offset:2048
    ds_read_b64_tr_b16 v[224:225], v25 offset:0
    ds_read_b64_tr_b16 v[226:227], v25 offset:2048
    v_mfma_f32_16x16x32_bf16 v[196:199], v[228:231], v[100:103], v[196:199]
    s_waitcnt lgkmcnt(10)
    v_mfma_f32_16x16x32_bf16 v[200:203], v[232:235], v[100:103], v[200:203]
    ds_read_b64_tr_b16 v[228:229], v26 offset:0
    ds_read_b64_tr_b16 v[230:231], v26 offset:2048
    ds_read_b64_tr_b16 v[232:233], v27 offset:0
    ds_read_b64_tr_b16 v[234:235], v27 offset:2048
    v_mfma_f32_16x16x32_bf16 v[188:191], v[236:239], v[104:107], v[188:191]
    s_waitcnt lgkmcnt(10)
    v_mfma_f32_16x16x32_bf16 v[192:195], v[240:243], v[104:107], v[192:195]
    ds_read_b64_tr_b16 v[236:237], v24 offset:4096
    ds_read_b64_tr_b16 v[238:239], v24 offset:6144
    ds_read_b64_tr_b16 v[240:241], v25 offset:4096
    ds_read_b64_tr_b16 v[242:243], v25 offset:6144
    v_mfma_f32_16x16x32_bf16 v[196:199], v[0:3], v[104:107], v[196:199]
    s_waitcnt lgkmcnt(10)
    v_mfma_f32_16x16x32_bf16 v[200:203], v[4:7], v[104:107], v[200:203]
    ds_read_b64_tr_b16 v[0:1], v26 offset:4096
    ds_read_b64_tr_b16 v[2:3], v26 offset:6144
    ds_read_b64_tr_b16 v[4:5], v27 offset:4096
    ds_read_b64_tr_b16 v[6:7], v27 offset:6144
    s_nop 7
    v_mul_f32 v188, v188, v247
    v_mul_f32 v189, v189, v247
    v_mul_f32 v190, v190, v247
    v_mul_f32 v191, v191, v247
    v_mul_f32 v192, v192, v247
    v_mul_f32 v193, v193, v247
    v_mul_f32 v194, v194, v247
    v_mul_f32 v195, v195, v247
    v_mul_f32 v196, v196, v247
    v_mul_f32 v197, v197, v247
    v_mul_f32 v198, v198, v247
    v_mul_f32 v199, v199, v247
    v_mul_f32 v200, v200, v247
    v_mul_f32 v201, v201, v247
    v_mul_f32 v202, v202, v247
    v_mul_f32 v203, v203, v247
    s_nop 0
    v_mfma_f32_16x16x32_bf16 v[188:191], v[220:223], v[76:79], v[188:191]
    s_waitcnt lgkmcnt(10)
    v_mfma_f32_16x16x32_bf16 v[192:195], v[224:227], v[76:79], v[192:195]
    ds_read_b64_tr_b16 v[220:221], v24 offset:8192
    ds_read_b64_tr_b16 v[222:223], v24 offset:10240
    ds_read_b64_tr_b16 v[224:225], v25 offset:8192
    ds_read_b64_tr_b16 v[226:227], v25 offset:10240
    v_mfma_f32_16x16x32_bf16 v[196:199], v[228:231], v[76:79], v[196:199]
    s_waitcnt lgkmcnt(10)
    v_mfma_f32_16x16x32_bf16 v[200:203], v[232:235], v[76:79], v[200:203]
    ds_read_b64_tr_b16 v[228:229], v26 offset:8192
    ds_read_b64_tr_b16 v[230:231], v26 offset:10240
    ds_read_b64_tr_b16 v[232:233], v27 offset:8192
    ds_read_b64_tr_b16 v[234:235], v27 offset:10240
    v_mfma_f32_16x16x32_bf16 v[188:191], v[236:239], v[80:83], v[188:191]
    s_waitcnt lgkmcnt(10)
    v_mfma_f32_16x16x32_bf16 v[192:195], v[240:243], v[80:83], v[192:195]
    ds_read_b64_tr_b16 v[236:237], v24 offset:12288
    ds_read_b64_tr_b16 v[238:239], v24 offset:14336
    ds_read_b64_tr_b16 v[240:241], v25 offset:12288
    ds_read_b64_tr_b16 v[242:243], v25 offset:14336
    v_mfma_f32_16x16x32_bf16 v[196:199], v[0:3], v[80:83], v[196:199]
    s_waitcnt lgkmcnt(10)
    v_mfma_f32_16x16x32_bf16 v[200:203], v[4:7], v[80:83], v[200:203]
    ds_read_b64_tr_b16 v[0:1], v26 offset:12288
    ds_read_b64_tr_b16 v[2:3], v26 offset:14336
    ds_read_b64_tr_b16 v[4:5], v27 offset:12288
    ds_read_b64_tr_b16 v[6:7], v27 offset:14336
    v_mfma_f32_16x16x32_bf16 v[188:191], v[220:223], v[84:87], v[188:191]
    s_waitcnt lgkmcnt(10)
    v_mfma_f32_16x16x32_bf16 v[192:195], v[224:227], v[84:87], v[192:195]
    v_add_u32 v24, 32768, v20
    v_add_u32 v25, 32768, v21
    v_add_u32 v26, 32768, v22
    v_add_u32 v27, 32768, v23
    s_barrier
    ds_read_b64_tr_b16 v[220:221], v24 offset:0
    ds_read_b64_tr_b16 v[222:223], v24 offset:2048
    ds_read_b64_tr_b16 v[224:225], v25 offset:0
    ds_read_b64_tr_b16 v[226:227], v25 offset:2048
    v_mfma_f32_16x16x32_bf16 v[196:199], v[228:231], v[84:87], v[196:199]
    s_waitcnt lgkmcnt(10)
    v_mfma_f32_16x16x32_bf16 v[200:203], v[232:235], v[84:87], v[200:203]
    ds_read_b64_tr_b16 v[228:229], v26 offset:0
    ds_read_b64_tr_b16 v[230:231], v26 offset:2048
    ds_read_b64_tr_b16 v[232:233], v27 offset:0
    ds_read_b64_tr_b16 v[234:235], v27 offset:2048
    v_mfma_f32_16x16x32_bf16 v[188:191], v[236:239], v[88:91], v[188:191]
    s_waitcnt lgkmcnt(10)
    v_mfma_f32_16x16x32_bf16 v[192:195], v[240:243], v[88:91], v[192:195]
    ds_read_b64_tr_b16 v[236:237], v24 offset:4096
    ds_read_b64_tr_b16 v[238:239], v24 offset:6144
    ds_read_b64_tr_b16 v[240:241], v25 offset:4096
    ds_read_b64_tr_b16 v[242:243], v25 offset:6144
    v_mfma_f32_16x16x32_bf16 v[196:199], v[0:3], v[88:91], v[196:199]
    s_waitcnt lgkmcnt(10)
    v_mfma_f32_16x16x32_bf16 v[200:203], v[4:7], v[88:91], v[200:203]
    ds_read_b64_tr_b16 v[0:1], v26 offset:4096
    ds_read_b64_tr_b16 v[2:3], v26 offset:6144
    ds_read_b64_tr_b16 v[4:5], v27 offset:4096
    ds_read_b64_tr_b16 v[6:7], v27 offset:6144
    s_nop 7
    v_mul_f32 v188, v188, v248
    v_mul_f32 v189, v189, v248
    v_mul_f32 v190, v190, v248
    v_mul_f32 v191, v191, v248
    v_mul_f32 v192, v192, v248
    v_mul_f32 v193, v193, v248
    v_mul_f32 v194, v194, v248
    v_mul_f32 v195, v195, v248
    v_mul_f32 v196, v196, v248
    v_mul_f32 v197, v197, v248
    v_mul_f32 v198, v198, v248
    v_mul_f32 v199, v199, v248
    v_mul_f32 v200, v200, v248
    v_mul_f32 v201, v201, v248
    v_mul_f32 v202, v202, v248
    v_mul_f32 v203, v203, v248
    s_nop 0
    v_mfma_f32_16x16x32_bf16 v[188:191], v[220:223], v[108:111], v[188:191]
    s_waitcnt lgkmcnt(10)
    v_mfma_f32_16x16x32_bf16 v[192:195], v[224:227], v[108:111], v[192:195]
    ds_read_b64_tr_b16 v[220:221], v24 offset:8192
    ds_read_b64_tr_b16 v[222:223], v24 offset:10240
    ds_read_b64_tr_b16 v[224:225], v25 offset:8192
    ds_read_b64_tr_b16 v[226:227], v25 offset:10240
    v_mfma_f32_16x16x32_bf16 v[196:199], v[228:231], v[108:111], v[196:199]
    s_waitcnt lgkmcnt(10)
    v_mfma_f32_16x16x32_bf16 v[200:203], v[232:235], v[108:111], v[200:203]
    ds_read_b64_tr_b16 v[228:229], v26 offset:8192
    ds_read_b64_tr_b16 v[230:231], v26 offset:10240
    ds_read_b64_tr_b16 v[232:233], v27 offset:8192
    ds_read_b64_tr_b16 v[234:235], v27 offset:10240
    v_mfma_f32_16x16x32_bf16 v[188:191], v[236:239], v[112:115], v[188:191]
    s_waitcnt lgkmcnt(10)
    v_mfma_f32_16x16x32_bf16 v[192:195], v[240:243], v[112:115], v[192:195]
    ds_read_b64_tr_b16 v[236:237], v24 offset:12288
    ds_read_b64_tr_b16 v[238:239], v24 offset:14336
    ds_read_b64_tr_b16 v[240:241], v25 offset:12288
    ds_read_b64_tr_b16 v[242:243], v25 offset:14336
    v_mfma_f32_16x16x32_bf16 v[196:199], v[0:3], v[112:115], v[196:199]
    s_waitcnt lgkmcnt(10)
    v_mfma_f32_16x16x32_bf16 v[200:203], v[4:7], v[112:115], v[200:203]
    ds_read_b64_tr_b16 v[0:1], v26 offset:12288
    ds_read_b64_tr_b16 v[2:3], v26 offset:14336
    ds_read_b64_tr_b16 v[4:5], v27 offset:12288
    ds_read_b64_tr_b16 v[6:7], v27 offset:14336
    v_mfma_f32_16x16x32_bf16 v[188:191], v[220:223], v[116:119], v[188:191]
    s_waitcnt lgkmcnt(10)
    v_mfma_f32_16x16x32_bf16 v[192:195], v[224:227], v[116:119], v[192:195]
    v_add_u32 v24, 49152, v20
    v_add_u32 v25, 49152, v21
    v_add_u32 v26, 49152, v22
    v_add_u32 v27, 49152, v23
    s_barrier
    ds_read_b64_tr_b16 v[220:221], v24 offset:0
    ds_read_b64_tr_b16 v[222:223], v24 offset:2048
    ds_read_b64_tr_b16 v[224:225], v25 offset:0
    ds_read_b64_tr_b16 v[226:227], v25 offset:2048
    v_mfma_f32_16x16x32_bf16 v[196:199], v[228:231], v[116:119], v[196:199]
    s_waitcnt lgkmcnt(10)
    v_mfma_f32_16x16x32_bf16 v[200:203], v[232:235], v[116:119], v[200:203]
    ds_read_b64_tr_b16 v[228:229], v26 offset:0
    ds_read_b64_tr_b16 v[230:231], v26 offset:2048
    ds_read_b64_tr_b16 v[232:233], v27 offset:0
    ds_read_b64_tr_b16 v[234:235], v27 offset:2048
    v_mfma_f32_16x16x32_bf16 v[188:191], v[236:239], v[120:123], v[188:191]
    s_waitcnt lgkmcnt(10)
    v_mfma_f32_16x16x32_bf16 v[192:195], v[240:243], v[120:123], v[192:195]
    ds_read_b64_tr_b16 v[236:237], v24 offset:4096
    ds_read_b64_tr_b16 v[238:239], v24 offset:6144
    ds_read_b64_tr_b16 v[240:241], v25 offset:4096
    ds_read_b64_tr_b16 v[242:243], v25 offset:6144
    v_mfma_f32_16x16x32_bf16 v[196:199], v[0:3], v[120:123], v[196:199]
    s_waitcnt lgkmcnt(10)
    v_mfma_f32_16x16x32_bf16 v[200:203], v[4:7], v[120:123], v[200:203]
    ds_read_b64_tr_b16 v[0:1], v26 offset:4096
    ds_read_b64_tr_b16 v[2:3], v26 offset:6144
    ds_read_b64_tr_b16 v[4:5], v27 offset:4096
    ds_read_b64_tr_b16 v[6:7], v27 offset:6144
    s_nop 7
    v_mul_f32 v188, v188, v249
    v_mul_f32 v189, v189, v249
    v_mul_f32 v190, v190, v249
    v_mul_f32 v191, v191, v249
    v_mul_f32 v192, v192, v249
    v_mul_f32 v193, v193, v249
    v_mul_f32 v194, v194, v249
    v_mul_f32 v195, v195, v249
    v_mul_f32 v196, v196, v249
    v_mul_f32 v197, v197, v249
    v_mul_f32 v198, v198, v249
    v_mul_f32 v199, v199, v249
    v_mul_f32 v200, v200, v249
    v_mul_f32 v201, v201, v249
    v_mul_f32 v202, v202, v249
    v_mul_f32 v203, v203, v249
    s_nop 0
    v_mfma_f32_16x16x32_bf16 v[188:191], v[220:223], v[124:127], v[188:191]
    s_waitcnt lgkmcnt(10)
    v_mfma_f32_16x16x32_bf16 v[192:195], v[224:227], v[124:127], v[192:195]
    ds_read_b64_tr_b16 v[220:221], v24 offset:8192
    ds_read_b64_tr_b16 v[222:223], v24 offset:10240
    ds_read_b64_tr_b16 v[224:225], v25 offset:8192
    ds_read_b64_tr_b16 v[226:227], v25 offset:10240
    v_mfma_f32_16x16x32_bf16 v[196:199], v[228:231], v[124:127], v[196:199]
    s_waitcnt lgkmcnt(10)
    v_mfma_f32_16x16x32_bf16 v[200:203], v[232:235], v[124:127], v[200:203]
    ds_read_b64_tr_b16 v[228:229], v26 offset:8192
    ds_read_b64_tr_b16 v[230:231], v26 offset:10240
    ds_read_b64_tr_b16 v[232:233], v27 offset:8192
    ds_read_b64_tr_b16 v[234:235], v27 offset:10240
    v_mfma_f32_16x16x32_bf16 v[188:191], v[236:239], v[128:131], v[188:191]
    s_waitcnt lgkmcnt(10)
    v_mfma_f32_16x16x32_bf16 v[192:195], v[240:243], v[128:131], v[192:195]
    ds_read_b64_tr_b16 v[236:237], v24 offset:12288
    ds_read_b64_tr_b16 v[238:239], v24 offset:14336
    ds_read_b64_tr_b16 v[240:241], v25 offset:12288
    ds_read_b64_tr_b16 v[242:243], v25 offset:14336
    v_mfma_f32_16x16x32_bf16 v[196:199], v[0:3], v[128:131], v[196:199]
    s_waitcnt lgkmcnt(10)
    v_mfma_f32_16x16x32_bf16 v[200:203], v[4:7], v[128:131], v[200:203]
    ds_read_b64_tr_b16 v[0:1], v26 offset:12288
    ds_read_b64_tr_b16 v[2:3], v26 offset:14336
    ds_read_b64_tr_b16 v[4:5], v27 offset:12288
    ds_read_b64_tr_b16 v[6:7], v27 offset:14336
    v_mfma_f32_16x16x32_bf16 v[188:191], v[220:223], v[132:135], v[188:191]
    s_waitcnt lgkmcnt(10)
    v_mfma_f32_16x16x32_bf16 v[192:195], v[224:227], v[132:135], v[192:195]
    v_add_u32 v24, 65536, v20
    v_add_u32 v25, 65536, v21
    v_add_u32 v26, 65536, v22
    v_add_u32 v27, 65536, v23
    s_barrier
    ds_read_b64_tr_b16 v[220:221], v24 offset:0
    ds_read_b64_tr_b16 v[222:223], v24 offset:2048
    ds_read_b64_tr_b16 v[224:225], v25 offset:0
    ds_read_b64_tr_b16 v[226:227], v25 offset:2048
    v_mfma_f32_16x16x32_bf16 v[196:199], v[228:231], v[132:135], v[196:199]
    s_waitcnt lgkmcnt(10)
    v_mfma_f32_16x16x32_bf16 v[200:203], v[232:235], v[132:135], v[200:203]
    ds_read_b64_tr_b16 v[228:229], v26 offset:0
    ds_read_b64_tr_b16 v[230:231], v26 offset:2048
    ds_read_b64_tr_b16 v[232:233], v27 offset:0
    ds_read_b64_tr_b16 v[234:235], v27 offset:2048
    v_mfma_f32_16x16x32_bf16 v[188:191], v[236:239], v[136:139], v[188:191]
    s_waitcnt lgkmcnt(10)
    v_mfma_f32_16x16x32_bf16 v[192:195], v[240:243], v[136:139], v[192:195]
    ds_read_b64_tr_b16 v[236:237], v24 offset:4096
    ds_read_b64_tr_b16 v[238:239], v24 offset:6144
    ds_read_b64_tr_b16 v[240:241], v25 offset:4096
    ds_read_b64_tr_b16 v[242:243], v25 offset:6144
    v_mfma_f32_16x16x32_bf16 v[196:199], v[0:3], v[136:139], v[196:199]
    s_waitcnt lgkmcnt(10)
    v_mfma_f32_16x16x32_bf16 v[200:203], v[4:7], v[136:139], v[200:203]
    ds_read_b64_tr_b16 v[0:1], v26 offset:4096
    ds_read_b64_tr_b16 v[2:3], v26 offset:6144
    ds_read_b64_tr_b16 v[4:5], v27 offset:4096
    ds_read_b64_tr_b16 v[6:7], v27 offset:6144
    s_nop 7
    v_mul_f32 v188, v188, v250
    v_mul_f32 v189, v189, v250
    v_mul_f32 v190, v190, v250
    v_mul_f32 v191, v191, v250
    v_mul_f32 v192, v192, v250
    v_mul_f32 v193, v193, v250
    v_mul_f32 v194, v194, v250
    v_mul_f32 v195, v195, v250
    v_mul_f32 v196, v196, v250
    v_mul_f32 v197, v197, v250
    v_mul_f32 v198, v198, v250
    v_mul_f32 v199, v199, v250
    v_mul_f32 v200, v200, v250
    v_mul_f32 v201, v201, v250
    v_mul_f32 v202, v202, v250
    v_mul_f32 v203, v203, v250
    s_nop 0
    v_mfma_f32_16x16x32_bf16 v[188:191], v[220:223], v[140:143], v[188:191]
    s_waitcnt lgkmcnt(10)
    v_mfma_f32_16x16x32_bf16 v[192:195], v[224:227], v[140:143], v[192:195]
    ds_read_b64_tr_b16 v[220:221], v24 offset:8192
    ds_read_b64_tr_b16 v[222:223], v24 offset:10240
    ds_read_b64_tr_b16 v[224:225], v25 offset:8192
    ds_read_b64_tr_b16 v[226:227], v25 offset:10240
    v_mfma_f32_16x16x32_bf16 v[196:199], v[228:231], v[140:143], v[196:199]
    s_waitcnt lgkmcnt(10)
    v_mfma_f32_16x16x32_bf16 v[200:203], v[232:235], v[140:143], v[200:203]
    ds_read_b64_tr_b16 v[228:229], v26 offset:8192
    ds_read_b64_tr_b16 v[230:231], v26 offset:10240
    ds_read_b64_tr_b16 v[232:233], v27 offset:8192
    ds_read_b64_tr_b16 v[234:235], v27 offset:10240
    v_mfma_f32_16x16x32_bf16 v[188:191], v[236:239], v[144:147], v[188:191]
    s_waitcnt lgkmcnt(10)
    v_mfma_f32_16x16x32_bf16 v[192:195], v[240:243], v[144:147], v[192:195]
    ds_read_b64_tr_b16 v[236:237], v24 offset:12288
    ds_read_b64_tr_b16 v[238:239], v24 offset:14336
    ds_read_b64_tr_b16 v[240:241], v25 offset:12288
    ds_read_b64_tr_b16 v[242:243], v25 offset:14336
    v_mfma_f32_16x16x32_bf16 v[196:199], v[0:3], v[144:147], v[196:199]
    s_waitcnt lgkmcnt(10)
    v_mfma_f32_16x16x32_bf16 v[200:203], v[4:7], v[144:147], v[200:203]
    ds_read_b64_tr_b16 v[0:1], v26 offset:12288
    ds_read_b64_tr_b16 v[2:3], v26 offset:14336
    ds_read_b64_tr_b16 v[4:5], v27 offset:12288
    ds_read_b64_tr_b16 v[6:7], v27 offset:14336
    v_mfma_f32_16x16x32_bf16 v[188:191], v[220:223], v[148:151], v[188:191]
    s_waitcnt lgkmcnt(10)
    v_mfma_f32_16x16x32_bf16 v[192:195], v[224:227], v[148:151], v[192:195]
    v_add_u32 v24, 81920, v20
    v_add_u32 v25, 81920, v21
    v_add_u32 v26, 81920, v22
    v_add_u32 v27, 81920, v23
    s_barrier
    ds_read_b64_tr_b16 v[220:221], v24 offset:0
    ds_read_b64_tr_b16 v[222:223], v24 offset:2048
    ds_read_b64_tr_b16 v[224:225], v25 offset:0
    ds_read_b64_tr_b16 v[226:227], v25 offset:2048
    v_mfma_f32_16x16x32_bf16 v[196:199], v[228:231], v[148:151], v[196:199]
    s_waitcnt lgkmcnt(10)
    v_mfma_f32_16x16x32_bf16 v[200:203], v[232:235], v[148:151], v[200:203]
    ds_read_b64_tr_b16 v[228:229], v26 offset:0
    ds_read_b64_tr_b16 v[230:231], v26 offset:2048
    ds_read_b64_tr_b16 v[232:233], v27 offset:0
    ds_read_b64_tr_b16 v[234:235], v27 offset:2048
    v_mfma_f32_16x16x32_bf16 v[188:191], v[236:239], v[152:155], v[188:191]
    s_waitcnt lgkmcnt(10)
    v_mfma_f32_16x16x32_bf16 v[192:195], v[240:243], v[152:155], v[192:195]
    ds_read_b64_tr_b16 v[236:237], v24 offset:4096
    ds_read_b64_tr_b16 v[238:239], v24 offset:6144
    ds_read_b64_tr_b16 v[240:241], v25 offset:4096
    ds_read_b64_tr_b16 v[242:243], v25 offset:6144
    v_mfma_f32_16x16x32_bf16 v[196:199], v[0:3], v[152:155], v[196:199]
    s_waitcnt lgkmcnt(10)
    v_mfma_f32_16x16x32_bf16 v[200:203], v[4:7], v[152:155], v[200:203]
    ds_read_b64_tr_b16 v[0:1], v26 offset:4096
    ds_read_b64_tr_b16 v[2:3], v26 offset:6144
    ds_read_b64_tr_b16 v[4:5], v27 offset:4096
    ds_read_b64_tr_b16 v[6:7], v27 offset:6144
    s_nop 7
    v_mul_f32 v188, v188, v251
    v_mul_f32 v189, v189, v251
    v_mul_f32 v190, v190, v251
    v_mul_f32 v191, v191, v251
    v_mul_f32 v192, v192, v251
    v_mul_f32 v193, v193, v251
    v_mul_f32 v194, v194, v251
    v_mul_f32 v195, v195, v251
    v_mul_f32 v196, v196, v251
    v_mul_f32 v197, v197, v251
    v_mul_f32 v198, v198, v251
    v_mul_f32 v199, v199, v251
    v_mul_f32 v200, v200, v251
    v_mul_f32 v201, v201, v251
    v_mul_f32 v202, v202, v251
    v_mul_f32 v203, v203, v251
    s_nop 0
    v_mfma_f32_16x16x32_bf16 v[188:191], v[220:223], v[156:159], v[188:191]
    s_waitcnt lgkmcnt(10)
    v_mfma_f32_16x16x32_bf16 v[192:195], v[224:227], v[156:159], v[192:195]
    ds_read_b64_tr_b16 v[220:221], v24 offset:8192
    ds_read_b64_tr_b16 v[222:223], v24 offset:10240
    ds_read_b64_tr_b16 v[224:225], v25 offset:8192
    ds_read_b64_tr_b16 v[226:227], v25 offset:10240
    v_mfma_f32_16x16x32_bf16 v[196:199], v[228:231], v[156:159], v[196:199]
    s_waitcnt lgkmcnt(10)
    v_mfma_f32_16x16x32_bf16 v[200:203], v[232:235], v[156:159], v[200:203]
    ds_read_b64_tr_b16 v[228:229], v26 offset:8192
    ds_read_b64_tr_b16 v[230:231], v26 offset:10240
    ds_read_b64_tr_b16 v[232:233], v27 offset:8192
    ds_read_b64_tr_b16 v[234:235], v27 offset:10240
    v_mfma_f32_16x16x32_bf16 v[188:191], v[236:239], v[160:163], v[188:191]
    s_waitcnt lgkmcnt(10)
    v_mfma_f32_16x16x32_bf16 v[192:195], v[240:243], v[160:163], v[192:195]
    ds_read_b64_tr_b16 v[236:237], v24 offset:12288
    ds_read_b64_tr_b16 v[238:239], v24 offset:14336
    ds_read_b64_tr_b16 v[240:241], v25 offset:12288
    ds_read_b64_tr_b16 v[242:243], v25 offset:14336
    v_mfma_f32_16x16x32_bf16 v[196:199], v[0:3], v[160:163], v[196:199]
    s_waitcnt lgkmcnt(10)
    v_mfma_f32_16x16x32_bf16 v[200:203], v[4:7], v[160:163], v[200:203]
    ds_read_b64_tr_b16 v[0:1], v26 offset:12288
    ds_read_b64_tr_b16 v[2:3], v26 offset:14336
    ds_read_b64_tr_b16 v[4:5], v27 offset:12288
    ds_read_b64_tr_b16 v[6:7], v27 offset:14336
    v_mfma_f32_16x16x32_bf16 v[188:191], v[220:223], v[164:167], v[188:191]
    s_waitcnt lgkmcnt(10)
    v_mfma_f32_16x16x32_bf16 v[192:195], v[224:227], v[164:167], v[192:195]
    s_cmp_lg_u32 s5, 0
    s_cbranch_scc1 L_pp0
    v_mov_b32 v58, s74
    buffer_load_dword v59, v58, s[52:55], 0 offen sc1
L_pp0:
    v_add_u32 v24, 98304, v20
    v_add_u32 v25, 98304, v21
    v_add_u32 v26, 98304, v22
    v_add_u32 v27, 98304, v23
    s_barrier
    ds_read_b64_tr_b16 v[220:221], v24 offset:0
    ds_read_b64_tr_b16 v[222:223], v24 offset:2048
    ds_read_b64_tr_b16 v[224:225], v25 offset:0
    ds_read_b64_tr_b16 v[226:227], v25 offset:2048
    v_mfma_f32_16x16x32_bf16 v[196:199], v[228:231], v[164:167], v[196:199]
    s_waitcnt lgkmcnt(10)
    v_mfma_f32_16x16x32_bf16 v[200:203], v[232:235], v[164:167], v[200:203]
    ds_read_b64_tr_b16 v[228:229], v26 offset:0
    ds_read_b64_tr_b16 v[230:231], v26 offset:2048
    ds_read_b64_tr_b16 v[232:233], v27 offset:0
    ds_read_b64_tr_b16 v[234:235], v27 offset:2048
    v_mfma_f32_16x16x32_bf16 v[188:191], v[236:239], v[168:171], v[188:191]
    s_waitcnt lgkmcnt(10)
    v_mfma_f32_16x16x32_bf16 v[192:195], v[240:243], v[168:171], v[192:195]
    ds_read_b64_tr_b16 v[236:237], v24 offset:4096
    ds_read_b64_tr_b16 v[238:239], v24 offset:6144
    ds_read_b64_tr_b16 v[240:241], v25 offset:4096
    ds_read_b64_tr_b16 v[242:243], v25 offset:6144
    v_mfma_f32_16x16x32_bf16 v[196:199], v[0:3], v[168:171], v[196:199]
    s_waitcnt lgkmcnt(10)
    v_mfma_f32_16x16x32_bf16 v[200:203], v[4:7], v[168:171], v[200:203]
    ds_read_b64_tr_b16 v[0:1], v26 offset:4096
    ds_read_b64_tr_b16 v[2:3], v26 offset:6144
    ds_read_b64_tr_b16 v[4:5], v27 offset:4096
    ds_read_b64_tr_b16 v[6:7], v27 offset:6144
    s_nop 7
    v_mul_f32 v188, v188, v252
    v_mul_f32 v189, v189, v252
    v_mul_f32 v190, v190, v252
    v_mul_f32 v191, v191, v252
    v_mul_f32 v192, v192, v252
    v_mul_f32 v193, v193, v252
    v_mul_f32 v194, v194, v252
    v_mul_f32 v195, v195, v252
    v_mul_f32 v196, v196, v252
    v_mul_f32 v197, v197, v252
    v_mul_f32 v198, v198, v252
    v_mul_f32 v199, v199, v252
    v_mul_f32 v200, v200, v252
    v_mul_f32 v201, v201, v252
    v_mul_f32 v202, v202, v252
    v_mul_f32 v203, v203, v252
    s_nop 0
    v_mfma_f32_16x16x32_bf16 v[188:191], v[220:223], v[172:175], v[188:191]
    s_waitcnt lgkmcnt(10)
    v_mfma_f32_16x16x32_bf16 v[192:195], v[224:227], v[172:175], v[192:195]
    ds_read_b64_tr_b16 v[220:221], v24 offset:8192
    ds_read_b64_tr_b16 v[222:223], v24 offset:10240
    ds_read_b64_tr_b16 v[224:225], v25 offset:8192
    ds_read_b64_tr_b16 v[226:227], v25 offset:10240
    v_mfma_f32_16x16x32_bf16 v[196:199], v[228:231], v[172:175], v[196:199]
    s_waitcnt lgkmcnt(10)
    v_mfma_f32_16x16x32_bf16 v[200:203], v[232:235], v[172:175], v[200:203]
    ds_read_b64_tr_b16 v[228:229], v26 offset:8192
    ds_read_b64_tr_b16 v[230:231], v26 offset:10240
    ds_read_b64_tr_b16 v[232:233], v27 offset:8192
    ds_read_b64_tr_b16 v[234:235], v27 offset:10240
    v_mfma_f32_16x16x32_bf16 v[188:191], v[236:239], v[176:179], v[188:191]
    s_waitcnt lgkmcnt(10)
    v_mfma_f32_16x16x32_bf16 v[192:195], v[240:243], v[176:179], v[192:195]
    ds_read_b64_tr_b16 v[236:237], v24 offset:12288
    ds_read_b64_tr_b16 v[238:239], v24 offset:14336
    ds_read_b64_tr_b16 v[240:241], v25 offset:12288
    ds_read_b64_tr_b16 v[242:243], v25 offset:14336
    v_mfma_f32_16x16x32_bf16 v[196:199], v[0:3], v[176:179], v[196:199]
    s_waitcnt lgkmcnt(10)
    v_mfma_f32_16x16x32_bf16 v[200:203], v[4:7], v[176:179], v[200:203]
    ds_read_b64_tr_b16 v[0:1], v26 offset:12288
    ds_read_b64_tr_b16 v[2:3], v26 offset:14336
    ds_read_b64_tr_b16 v[4:5], v27 offset:12288
    ds_read_b64_tr_b16 v[6:7], v27 offset:14336
    v_mfma_f32_16x16x32_bf16 v[188:191], v[220:223], v[180:183], v[188:191]
    s_waitcnt lgkmcnt(10)
    v_mfma_f32_16x16x32_bf16 v[192:195], v[224:227], v[180:183], v[192:195]
    s_cmp_lg_u32 s5, 0
    s_cbranch_scc1 L_pp1
    v_mov_b32 v58, 114704
    s_waitcnt vmcnt(0)
    ds_write_b32 v58, v59
    s_waitcnt lgkmcnt(0)
L_pp1:
    v_mov_b32 v24, v20
    v_mov_b32 v25, v21
    v_mov_b32 v26, v22
    v_mov_b32 v27, v23
    s_barrier
    v_mov_b32 v58, 114704
    ds_read_b32 v59, v58
    v_mbcnt_lo_u32_b32 v54, -1, 0
    v_mbcnt_hi_u32_b32 v54, -1, v54
    v_lshlrev_b32 v58, 4, v54
    s_waitcnt lgkmcnt(0)
    v_readfirstlane_b32 s72, v59
    v_lshlrev_b32 v59, 3, v54
    s_nop 2
    s_lshr_b32 s72, s72, s75
    s_and_b32 s63, s72, 0xff
    s_cmp_eq_u32 s63, 1
    s_cbranch_scc0 L_pp2
    buffer_load_dwordx4 v[28:31], v58, s[48:51], s67 offen offset:0 sc1
    buffer_load_dwordx4 v[32:35], v58, s[48:51], s67 offen offset:1024 sc1
    buffer_load_dwordx4 v[36:39], v58, s[48:51], s67 offen offset:2048 sc1
    buffer_load_dwordx4 v[40:43], v58, s[48:51], s67 offen offset:3072 sc1
    buffer_load_dwordx2 v[44:45], v59, s[48:51], s68 offen sc1
L_pp2:
    ds_read_b64_tr_b16 v[220:221], v24 offset:0
    ds_read_b64_tr_b16 v[222:223], v24 offset:2048
    ds_read_b64_tr_b16 v[224:225], v25 offset:0
    ds_read_b64_tr_b16 v[226:227], v25 offset:2048
    v_mfma_f32_16x16x32_bf16 v[196:199], v[228:231], v[180:183], v[196:199]
    ds_read_b64_tr_b16 v[228:229], v26 offset:0
    ds_read_b64_tr_b16 v[230:231], v26 offset:2048
    v_mfma_f32_16x16x32_bf16 v[200:203], v[232:235], v[180:183], v[200:203]
    ds_read_b64_tr_b16 v[232:233], v27 offset:0
    ds_read_b64_tr_b16 v[234:235], v27 offset:2048
    v_mfma_f32_16x16x32_bf16 v[188:191], v[236:239], v[184:187], v[188:191]
    v_mfma_f32_16x16x32_bf16 v[192:195], v[240:243], v[184:187], v[192:195]
    v_mfma_f32_16x16x32_bf16 v[196:199], v[0:3], v[184:187], v[196:199]
    v_mfma_f32_16x16x32_bf16 v[200:203], v[4:7], v[184:187], v[200:203]
    s_nop 1
    s_nop 7
    v_mul_f32 v188, v188, v52
    v_mul_f32 v189, v189, v52
    v_mul_f32 v190, v190, v52
    v_mul_f32 v191, v191, v52
    v_mul_f32 v192, v192, v52
    v_mul_f32 v193, v193, v52
    v_mul_f32 v194, v194, v52
    v_mul_f32 v195, v195, v52
    v_mul_f32 v196, v196, v52
    v_mul_f32 v197, v197, v52
    v_mul_f32 v198, v198, v52
    v_mul_f32 v199, v199, v52
    v_mul_f32 v200, v200, v52
    v_mul_f32 v201, v201, v52
    v_mul_f32 v202, v202, v52
    v_mul_f32 v203, v203, v52
    v_mul_f32 v12, v12, v52
    v_mul_f32 v13, v13, v52
    v_mul_f32 v14, v14, v52
    v_mul_f32 v15, v15, v52
    s_nop 0
    s_waitcnt lgkmcnt(4)
    v_mfma_f32_16x16x32_bf16 v[188:191], v[220:223], v[48:51], v[188:191]
    v_mfma_f32_16x16x32_bf16 v[192:195], v[224:227], v[48:51], v[192:195]
    s_waitcnt lgkmcnt(0)
    v_mfma_f32_16x16x32_bf16 v[196:199], v[228:231], v[48:51], v[196:199]
    v_mfma_f32_16x16x32_bf16 v[200:203], v[232:235], v[48:51], v[200:203]
    v_mfma_f32_16x16x32_bf16 v[12:15], v[8:11], v[48:51], v[12:15]
    v_mbcnt_lo_u32_b32 v253, -1, 0
    v_mbcnt_hi_u32_b32 v253, -1, v253
    s_cmp_eq_u32 s63, 1
    s_cbranch_scc1 L_have
    v_lshlrev_b32 v58, 4, v253
    v_lshlrev_b32 v59, 3, v253
    s_cmp_lg_u32 s5, 0
    s_cbranch_scc1 L_got
    v_mov_b32 v254, s74
L_poll:
    buffer_load_dword v255, v254, s[52:55], 0 offen sc1
    s_waitcnt vmcnt(0)
    v_readfirstlane_b32 s72, v255
    s_nop 3
    s_lshr_b32 s72, s72, s75
    s_and_b32 s72, s72, 0xff
    s_cmp_eq_u32 s72, 1
    s_cbranch_scc1 L_got
    s_sleep 1
    s_branch L_poll
L_got:
    s_barrier
    buffer_load_dwordx4 v[28:31], v58, s[48:51], s67 offen offset:0 sc1
    buffer_load_dwordx4 v[32:35], v58, s[48:51], s67 offen offset:1024 sc1
    buffer_load_dwordx4 v[36:39], v58, s[48:51], s67 offen offset:2048 sc1
    buffer_load_dwordx4 v[40:43], v58, s[48:51], s67 offen offset:3072 sc1
    buffer_load_dwordx2 v[44:45], v59, s[48:51], s68 offen sc1
L_have:
    v_and_b32 v254, 15, v253
    v_lshrrev_b32 v253, 4, v253
    v_lshlrev_b32 v253, 3, v253
    v_lshl_add_u32 v253, v254, 9, v253
    s_waitcnt vmcnt(0)
    v_max_f32 v56, v244, v44
    v_sub_f32 v54, v244, v56
    v_sub_f32 v55, v44, v56
    v_exp_f32 v54, v54
    v_exp_f32 v55, v55
    s_nop 0
    v_mul_f32 v57, v54, v12
    v_fmac_f32 v57, v55, v45
    v_rcp_f32 v57, v57
    s_nop 0
    v_mul_f32 v54, v54, v57
    v_mul_f32 v55, v55, v57
    v_mul_f32 v188, v188, v54
    v_fmac_f32 v188, v28, v55
    v_mul_f32 v189, v189, v54
    v_fmac_f32 v189, v29, v55
    v_mul_f32 v190, v190, v54
    v_fmac_f32 v190, v30, v55
    v_mul_f32 v191, v191, v54
    v_fmac_f32 v191, v31, v55
    v_cvt_pk_bf16_f32 v188, v188, v189
    v_cvt_pk_bf16_f32 v189, v190, v191
    buffer_store_dwordx2 v[188:189], v253, s[44:47], s70 offen offset:0
    v_mul_f32 v192, v192, v54
    v_fmac_f32 v192, v32, v55
    v_mul_f32 v193, v193, v54
    v_fmac_f32 v193, v33, v55
    v_mul_f32 v194, v194, v54
    v_fmac_f32 v194, v34, v55
    v_mul_f32 v195, v195, v54
    v_fmac_f32 v195, v35, v55
    v_cvt_pk_bf16_f32 v192, v192, v193
    v_cvt_pk_bf16_f32 v193, v194, v195
    buffer_store_dwordx2 v[192:193], v253, s[44:47], s70 offen offset:32
    v_mul_f32 v196, v196, v54
    v_fmac_f32 v196, v36, v55
    v_mul_f32 v197, v197, v54
    v_fmac_f32 v197, v37, v55
    v_mul_f32 v198, v198, v54
    v_fmac_f32 v198, v38, v55
    v_mul_f32 v199, v199, v54
    v_fmac_f32 v199, v39, v55
    v_cvt_pk_bf16_f32 v196, v196, v197
    v_cvt_pk_bf16_f32 v197, v198, v199
    buffer_store_dwordx2 v[196:197], v253, s[44:47], s70 offen offset:64
    v_mul_f32 v200, v200, v54
    v_fmac_f32 v200, v40, v55
    v_mul_f32 v201, v201, v54
    v_fmac_f32 v201, v41, v55
    v_mul_f32 v202, v202, v54
    v_fmac_f32 v202, v42, v55
    v_mul_f32 v203, v203, v54
    v_fmac_f32 v203, v43, v55
    v_cvt_pk_bf16_f32 v200, v200, v201
    v_cvt_pk_bf16_f32 v201, v202, v203
    buffer_store_dwordx2 v[200:201], v253, s[44:47], s70 offen offset:96
L_end:
    s_endpgm
.section .rodata,"a"
.p2align 6
.amdhsa_kernel standalone__tree_speculative_verify_tree_attention_over_candidate_token_tree__sampling_kernel
  .amdhsa_next_free_vgpr 256
  .amdhsa_next_free_sgpr 102
  .amdhsa_accum_offset 256
  .amdhsa_group_segment_fixed_size 0
  .amdhsa_kernarg_size 72
  .amdhsa_user_sgpr_count 2
  .amdhsa_user_sgpr_kernarg_segment_ptr 1
  .amdhsa_system_sgpr_workgroup_id_x 1
.end_amdhsa_kernel
```
